```python
import torch

def _softmax(x, axis=-1):
    return torch.softmax(x, dim=axis)
def _gelu(x):
    return torch.nn.functional.gelu(x, approximate="tanh")
def _silu(x):
    return torch.nn.functional.silu(x)
def _sigmoid(x):
    return torch.sigmoid(x)
def _layernorm(x, axis=-1, eps=1e-5):
    m = x.mean(dim=axis, keepdim=True)
    v = x.var(dim=axis, keepdim=True, unbiased=False)
    return (x - m) / torch.sqrt(v + eps)
def _scatter_add(tgt, idx, src, axis=0):
    return tgt.clone().index_add_(axis, idx, src)
def _segment_sum(src, seg, n):
    out = torch.zeros((n,) + src.shape[1:], dtype=src.dtype)
    return out.index_add_(0, seg, src)
def _pad(x, pw):
    flat = tuple(v for pair in reversed(pw) for v in pair)
    return torch.nn.functional.pad(x, flat)

kernel_name = 'sequential_preLN__gqa_block_cached__glu_gated_geglu__decode'

def setup_inputs():

    _w = (lambda a: (lambda t: t.to(torch.bfloat16) if t.is_floating_point() else t)(torch.as_tensor(a)))
    def _A_setup():
        B, Sq, D = 1, 1, 1024
        Hq, Hkv, Sk, Dh = 32, 4, 65536, 128
        assert Hq % Hkv == 0, (Hq, Hkv)
        return {
            "x": _w((lambda *s: torch.randn(*s, dtype=torch.bfloat16) * 0.05)(B, Sq, D)),
            "k_cache": _w((lambda *s: torch.randn(*s, dtype=torch.bfloat16) * 3.2)(B, Hkv, Sk, Dh)),
            "v_cache": _w((lambda *s: torch.randn(*s, dtype=torch.bfloat16) * 1.6)(B, Hkv, Sk, Dh)),
            "wq": _w((lambda *s: torch.randn(*s, dtype=torch.bfloat16) * 3.2)(D, Hq * Dh) * (D ** -0.5)),
            "wo": _w((lambda *s: torch.randn(*s, dtype=torch.bfloat16) * 1.6)(Hq * Dh, D) * ((Hq * Dh) ** -0.5)),
        }
    _A_in = _A_setup()

    def _B_setup():
        B, S, Dm, Df = 1, 1, 1024, 3584
        return {
            "x": _w((lambda *s: torch.randn(*s, dtype=torch.bfloat16) * 0.05)(B, S, Dm)),
            "w_gate": _w((lambda *s: torch.randn(*s, dtype=torch.bfloat16) * 1.6)(Dm, Df) * (Dm ** -0.5)),
            "w_up": _w((lambda *s: torch.randn(*s, dtype=torch.bfloat16) * 1.6)(Dm, Df) * (Dm ** -0.5)),
            "w_down": _w((lambda *s: torch.randn(*s, dtype=torch.bfloat16) * 1.6)(Df, Dm) * (Df ** -0.5)),
        }
    _B_in = _B_setup()

    return {
        "A_x": _A_in["x"],
        "A_k_cache": _A_in["k_cache"],
        "A_v_cache": _A_in["v_cache"],
        "A_wq": _A_in["wq"],
        "A_wo": _A_in["wo"],
        "B_x": _B_in["x"],
        "B_w_gate": _B_in["w_gate"],
        "B_w_up": _B_in["w_up"],
        "B_w_down": _B_in["w_down"],
    }

def reference(A_x, A_k_cache, A_v_cache, A_wq, A_wo, B_x, B_w_gate, B_w_up, B_w_down):
    def _A_ref(x, k_cache, v_cache, wq, wo):
        B, Sq, D = x.shape
        Hq, Dh = 32, 128
        Hkv = k_cache.shape[1]
        rep = Hq // Hkv
        q = (lambda x, *d: x.permute(*d))((x @ wq).reshape(B, Sq, Hq, Dh), 0, 2, 1, 3)
        k = (lambda x, n, axis: torch.repeat_interleave(x, n, dim=axis))(k_cache, rep, axis=1)
        v = (lambda x, n, axis: torch.repeat_interleave(x, n, dim=axis))(v_cache, rep, axis=1)
        scores = torch.einsum("bhqd,bhkd->bhqk", q, k) * (Dh ** -0.5)
        p = _softmax(scores, axis=-1)
        o = torch.einsum("bhqk,bhkd->bhqd", p, v)
        return (lambda x, *d: x.permute(*d))(o, 0, 2, 1, 3).reshape(B, Sq, Hq * Dh) @ wo

    def _B_ref(x, w_gate, w_up, w_down):
        g = torch.einsum("bsd,df->bsf", x, w_gate)
        u = torch.einsum("bsd,df->bsf", x, w_up)
        h = _gelu(g) * u
        return torch.einsum("bsf,fd->bsd", h, w_down)

    x = A_x
    h = x + _A_ref(_layernorm(x, axis=-1), A_k_cache, A_v_cache, A_wq, A_wo)
    h2 = h + _B_ref(_layernorm(h, axis=-1), B_w_gate, B_w_up, B_w_down)
    return h2
```

```asm
; @launch grid=(256,1,1) block=(512,1,1) lds=131072
.amdgcn_target "amdgcn-amd-amdhsa--gfx950"
.text
.globl sequential_preLN__gqa_block_cached__glu_gated_geglu__decode_kernel
.p2align 8
.type sequential_preLN__gqa_block_cached__glu_gated_geglu__decode_kernel,@function
sequential_preLN__gqa_block_cached__glu_gated_geglu__decode_kernel:
    s_cmp_ge_u32 s2, 256
    s_cbranch_scc1 L_exit
    s_load_dwordx16 s[16:31], s[0:1], 0
    s_load_dwordx8 s[32:39], s[0:1], 64
    v_lshrrev_b32 v8, 6, v0
    v_and_b32 v0, 63, v0
    v_readfirstlane_b32 s3, v8
    v_mov_b32 v7, 0
    v_and_b32 v1, 15, v0
    v_lshrrev_b32 v2, 4, v0
    v_mov_b32 v8, 0
    v_mov_b32 v9, 0
    v_mov_b32 v10, 0
    v_mov_b32 v11, 0
    s_cmp_lg_u32 s3, 0
    s_cbranch_scc1 L_nozero
    ds_write_b128 v7, v[8:11]
    ds_write_b128 v7, v[8:11] offset:16
    ds_write_b128 v7, v[8:11] offset:32
    ds_write_b128 v7, v[8:11] offset:48
L_nozero:
    s_and_b32 s4, s2, 7
    s_lshr_b32 s5, s2, 3
    s_lshr_b32 s8, s4, 1
    s_and_b32 s9, s4, 1
    s_lshl_b32 s7, s9, 4
    s_and_b32 s96, s5, 15
    s_add_u32 s7, s7, s96
    s_lshl_b32 s9, s9, 5
    s_add_u32 s9, s9, s5
    s_lshl_b32 s6, s8, 6
    s_add_u32 s6, s6, s9
    s_and_b32 s67, s3, 3
    s_mov_b32 s12, 0x05040100
    s_mov_b32 s13, 0x07060302
    s_mov_b32 s14, 0xfffffc00
    s_mov_b32 s15, 0xffff0000
    s_mov_b32 s76, 200000
    s_mov_b32 s79, 0x3fb8aa3b
    s_mov_b32 s64, 0x3db504f3
    s_lshl_b32 s77, s8, 24
    s_lshl_b32 s96, s9, 2
    s_add_u32 s96, s96, s67
    s_lshl_b32 s96, s96, 13
    s_add_u32 s77, s77, s96
    s_mul_i32 s65, s67, 24576
    s_add_u32 s65, s65, 32768
    v_and_b32 v12, 3, v1
    v_lshlrev_b32 v12, 10, v12
    v_bfe_u32 v13, v1, 2, 1
    v_lshl_add_u32 v12, v13, 8, v12
    v_lshrrev_b32 v13, 3, v1
    v_lshl_add_u32 v12, v13, 6, v12
    v_lshl_add_u32 v3, v2, 4, v12
    v_lshlrev_b32 v4, 4, v0
    s_waitcnt lgkmcnt(0)
    s_load_dword s78, s[38:39], 0
    s_mov_b32 s72, s38
    s_and_b32 s73, s39, 0xffff
    s_mov_b32 s74, 0x600000
    s_mov_b32 s75, 0x20000
    s_cmp_ge_u32 s3, 4
    s_cbranch_scc1 L_helper
    s_mov_b32 s44, s18
    s_and_b32 s45, s19, 0xffff
    s_mov_b32 s46, 0x4000000
    s_mov_b32 s47, 0x20000
    s_mov_b32 s48, s20
    s_and_b32 s49, s21, 0xffff
    s_mov_b32 s50, 0x4000000
    s_mov_b32 s51, 0x20000
    s_and_b32 s96, s7, 14
    s_cmp_eq_u32 s96, 6
    s_cselect_b32 s37, 2, 1
    s_cmp_ge_u32 s6, 254
    s_cselect_b32 s37, 2, s37
    s_cmp_lt_u32 s5, 16
    s_cselect_b32 s37, 0, s37
    s_mov_b32 s36, s37
    s_add_u32 s96, s77, 0x0
    s_add_u32 m0, s65, 0x0
    s_nop 0
    buffer_load_dwordx4 v3, s[44:47], s96 offen nt lds
    s_add_u32 s96, s77, 0x80
    s_add_u32 m0, s65, 0x400
    s_nop 0
    buffer_load_dwordx4 v3, s[44:47], s96 offen nt lds
    s_add_u32 s96, s77, 0x200
    s_add_u32 m0, s65, 0x800
    s_nop 0
    buffer_load_dwordx4 v3, s[44:47], s96 offen nt lds
    s_add_u32 s96, s77, 0x280
    s_add_u32 m0, s65, 0xc00
    s_nop 0
    buffer_load_dwordx4 v3, s[44:47], s96 offen nt lds
    s_barrier
    s_waitcnt lgkmcnt(0)
    s_add_u32 s78, s78, 1
    s_and_b32 s10, s78, 0xffff
    s_and_b32 s11, s78, 0x3ff
    v_mov_b32 v6, s11
    s_add_u32 s96, s77, 0x1000
    s_add_u32 m0, s65, 0x1000
    s_nop 0
    buffer_load_dwordx4 v3, s[44:47], s96 offen nt lds
    s_add_u32 s96, s77, 0x1080
    s_add_u32 m0, s65, 0x1400
    s_cmp_gt_u32 s36, 0
    s_cbranch_scc1 L_th_1
    s_waitcnt vmcnt(4)
L_th_1:
    buffer_load_dwordx4 v3, s[44:47], s96 offen nt lds
    s_add_u32 s96, s77, 0x1200
    s_add_u32 m0, s65, 0x1800
    s_cmp_gt_u32 s36, 0
    s_cbranch_scc1 L_th_2
    s_waitcnt vmcnt(4)
L_th_2:
    buffer_load_dwordx4 v3, s[44:47], s96 offen nt lds
    s_add_u32 s96, s77, 0x1280
    s_add_u32 m0, s65, 0x1c00
    s_cmp_gt_u32 s36, 1
    s_cbranch_scc1 L_th_3
    s_waitcnt vmcnt(5)
    s_cmp_gt_u32 s36, 0
    s_cbranch_scc1 L_th_3
    s_waitcnt vmcnt(4)
L_th_3:
    buffer_load_dwordx4 v3, s[44:47], s96 offen nt lds
    s_add_u32 s96, s77, 0x200000
    s_add_u32 m0, s65, 0x2000
    s_waitcnt vmcnt(7)
    s_cmp_gt_u32 s36, 1
    s_cbranch_scc1 L_th_4
    s_waitcnt vmcnt(6)
    s_cmp_gt_u32 s36, 0
    s_cbranch_scc1 L_th_4
    s_waitcnt vmcnt(4)
L_th_4:
    buffer_load_dwordx4 v3, s[44:47], s96 offen nt lds
    s_add_u32 s96, s77, 0x200080
    s_add_u32 m0, s65, 0x2400
    s_waitcnt vmcnt(7)
    s_cmp_gt_u32 s36, 1
    s_cbranch_scc1 L_th_5
    s_waitcnt vmcnt(5)
    s_cmp_gt_u32 s36, 0
    s_cbranch_scc1 L_th_5
    s_waitcnt vmcnt(4)
L_th_5:
    buffer_load_dwordx4 v3, s[44:47], s96 offen nt lds
    s_add_u32 s96, s77, 0x200200
    s_add_u32 m0, s65, 0x2800
    s_waitcnt vmcnt(7)
    s_cmp_gt_u32 s36, 1
    s_cbranch_scc1 L_th_6
    s_waitcnt vmcnt(6)
    s_cmp_gt_u32 s36, 0
    s_cbranch_scc1 L_th_6
    s_waitcnt vmcnt(4)
L_th_6:
    buffer_load_dwordx4 v3, s[44:47], s96 offen nt lds
    s_add_u32 s96, s77, 0x200280
    s_add_u32 m0, s65, 0x2c00
    s_waitcnt vmcnt(7)
    s_cmp_gt_u32 s36, 1
    s_cbranch_scc1 L_th_7
    s_waitcnt vmcnt(5)
    s_cmp_gt_u32 s36, 0
    s_cbranch_scc1 L_th_7
    s_waitcnt vmcnt(4)
L_th_7:
    buffer_load_dwordx4 v3, s[44:47], s96 offen nt lds
    s_add_u32 s96, s77, 0x201000
    s_add_u32 m0, s65, 0x3000
    s_waitcnt vmcnt(7)
    s_cmp_gt_u32 s36, 1
    s_cbranch_scc1 L_th_8
    s_waitcnt vmcnt(6)
    s_cmp_gt_u32 s36, 0
    s_cbranch_scc1 L_th_8
    s_waitcnt vmcnt(4)
L_th_8:
    buffer_load_dwordx4 v3, s[44:47], s96 offen nt lds
    s_add_u32 s96, s77, 0x201080
    s_add_u32 m0, s65, 0x3400
    s_waitcnt vmcnt(7)
    s_cmp_gt_u32 s36, 1
    s_cbranch_scc1 L_th_9
    s_waitcnt vmcnt(5)
    s_cmp_gt_u32 s36, 0
    s_cbranch_scc1 L_th_9
    s_waitcnt vmcnt(4)
L_th_9:
    buffer_load_dwordx4 v3, s[44:47], s96 offen nt lds
    s_add_u32 s96, s77, 0x201200
    s_add_u32 m0, s65, 0x3800
    s_waitcnt vmcnt(7)
    s_cmp_gt_u32 s36, 1
    s_cbranch_scc1 L_th_10
    s_waitcnt vmcnt(6)
    s_cmp_gt_u32 s36, 0
    s_cbranch_scc1 L_th_10
    s_waitcnt vmcnt(4)
L_th_10:
    buffer_load_dwordx4 v3, s[44:47], s96 offen nt lds
    s_add_u32 s96, s77, 0x201280
    s_add_u32 m0, s65, 0x3c00
    s_waitcnt vmcnt(7)
    s_cmp_gt_u32 s36, 1
    s_cbranch_scc1 L_th_11
    s_waitcnt vmcnt(5)
    s_cmp_gt_u32 s36, 0
    s_cbranch_scc1 L_th_11
    s_waitcnt vmcnt(4)
L_th_11:
    buffer_load_dwordx4 v3, s[44:47], s96 offen nt lds
    s_add_u32 s96, s77, 0x400000
    s_add_u32 m0, s65, 0x4000
    s_waitcnt vmcnt(7)
    s_cmp_gt_u32 s36, 1
    s_cbranch_scc1 L_th_12
    s_waitcnt vmcnt(6)
    s_cmp_gt_u32 s36, 0
    s_cbranch_scc1 L_th_12
    s_waitcnt vmcnt(4)
L_th_12:
    buffer_load_dwordx4 v3, s[44:47], s96 offen nt lds
    s_add_u32 s96, s77, 0x400080
    s_add_u32 m0, s65, 0x4400
    s_waitcnt vmcnt(7)
    s_cmp_gt_u32 s36, 1
    s_cbranch_scc1 L_th_13
    s_waitcnt vmcnt(5)
    s_cmp_gt_u32 s36, 0
    s_cbranch_scc1 L_th_13
    s_waitcnt vmcnt(4)
L_th_13:
    buffer_load_dwordx4 v3, s[44:47], s96 offen nt lds
    s_add_u32 s96, s77, 0x400200
    s_add_u32 m0, s65, 0x4800
    s_waitcnt vmcnt(7)
    s_cmp_gt_u32 s36, 1
    s_cbranch_scc1 L_th_14
    s_waitcnt vmcnt(6)
    s_cmp_gt_u32 s36, 0
    s_cbranch_scc1 L_th_14
    s_waitcnt vmcnt(4)
L_th_14:
    buffer_load_dwordx4 v3, s[44:47], s96 offen nt lds
    s_add_u32 s96, s77, 0x400280
    s_add_u32 m0, s65, 0x4c00
    s_waitcnt vmcnt(7)
    s_cmp_gt_u32 s36, 1
    s_cbranch_scc1 L_th_15
    s_waitcnt vmcnt(5)
    s_cmp_gt_u32 s36, 0
    s_cbranch_scc1 L_th_15
    s_waitcnt vmcnt(4)
L_th_15:
    buffer_load_dwordx4 v3, s[44:47], s96 offen nt lds
    s_add_u32 s96, s77, 0x401000
    s_add_u32 m0, s65, 0x5000
    s_waitcnt vmcnt(7)
    s_cmp_gt_u32 s36, 1
    s_cbranch_scc1 L_th_16
    s_waitcnt vmcnt(6)
    s_cmp_gt_u32 s36, 0
    s_cbranch_scc1 L_th_16
    s_waitcnt vmcnt(4)
L_th_16:
    buffer_load_dwordx4 v3, s[44:47], s96 offen nt lds
    s_add_u32 s96, s77, 0x401080
    s_add_u32 m0, s65, 0x5400
    s_waitcnt vmcnt(7)
    s_cmp_gt_u32 s36, 1
    s_cbranch_scc1 L_th_17
    s_waitcnt vmcnt(5)
    s_cmp_gt_u32 s36, 0
    s_cbranch_scc1 L_th_17
    s_waitcnt vmcnt(4)
L_th_17:
    buffer_load_dwordx4 v3, s[44:47], s96 offen nt lds
    s_add_u32 s96, s77, 0x401200
    s_add_u32 m0, s65, 0x5800
    s_waitcnt vmcnt(7)
    s_cmp_gt_u32 s36, 1
    s_cbranch_scc1 L_th_18
    s_waitcnt vmcnt(6)
    s_cmp_gt_u32 s36, 0
    s_cbranch_scc1 L_th_18
    s_waitcnt vmcnt(4)
L_th_18:
    buffer_load_dwordx4 v3, s[44:47], s96 offen nt lds
    s_add_u32 s96, s77, 0x401280
    s_add_u32 m0, s65, 0x5c00
    s_waitcnt vmcnt(7)
    s_cmp_gt_u32 s36, 1
    s_cbranch_scc1 L_th_19
    s_waitcnt vmcnt(5)
    s_cmp_gt_u32 s36, 0
    s_cbranch_scc1 L_th_19
    s_waitcnt vmcnt(4)
L_th_19:
    buffer_load_dwordx4 v3, s[44:47], s96 offen nt lds
    s_add_u32 s96, s77, 0x600000
    s_waitcnt vmcnt(7)
    s_cmp_gt_u32 s36, 1
    s_cbranch_scc1 L_th_20
    s_waitcnt vmcnt(6)
    s_cmp_gt_u32 s36, 0
    s_cbranch_scc1 L_th_20
    s_waitcnt vmcnt(4)
L_th_20:
    buffer_load_dwordx4 v[96:99], v3, s[44:47], s96 offen offset:0 nt
    s_add_u32 s96, s77, 0x600000
    s_waitcnt vmcnt(7)
    s_cmp_gt_u32 s36, 1
    s_cbranch_scc1 L_th_21
    s_waitcnt vmcnt(5)
    s_cmp_gt_u32 s36, 0
    s_cbranch_scc1 L_th_21
    s_waitcnt vmcnt(4)
L_th_21:
    buffer_load_dwordx4 v[100:103], v3, s[44:47], s96 offen offset:128 nt
    s_add_u32 s96, s77, 0x600000
    s_waitcnt vmcnt(7)
    s_cmp_gt_u32 s36, 1
    s_cbranch_scc1 L_th_22
    s_waitcnt vmcnt(6)
    s_cmp_gt_u32 s36, 0
    s_cbranch_scc1 L_th_22
    s_waitcnt vmcnt(4)
L_th_22:
    buffer_load_dwordx4 v[104:107], v3, s[44:47], s96 offen offset:512 nt
    s_add_u32 s96, s77, 0x600000
    s_waitcnt vmcnt(7)
    s_cmp_gt_u32 s36, 1
    s_cbranch_scc1 L_th_23
    s_waitcnt vmcnt(5)
    s_cmp_gt_u32 s36, 0
    s_cbranch_scc1 L_th_23
    s_waitcnt vmcnt(4)
L_th_23:
    buffer_load_dwordx4 v[108:111], v3, s[44:47], s96 offen offset:640 nt
    s_add_u32 s96, s77, 0x601000
    s_waitcnt vmcnt(7)
    s_cmp_gt_u32 s36, 1
    s_cbranch_scc1 L_th_24
    s_waitcnt vmcnt(6)
    s_cmp_gt_u32 s36, 0
    s_cbranch_scc1 L_th_24
    s_waitcnt vmcnt(4)
L_th_24:
    buffer_load_dwordx4 v[112:115], v3, s[44:47], s96 offen offset:0 nt
    s_add_u32 s96, s77, 0x601000
    s_waitcnt vmcnt(7)
    s_cmp_gt_u32 s36, 1
    s_cbranch_scc1 L_th_25
    s_waitcnt vmcnt(5)
    s_cmp_gt_u32 s36, 0
    s_cbranch_scc1 L_th_25
    s_waitcnt vmcnt(4)
L_th_25:
    buffer_load_dwordx4 v[116:119], v3, s[44:47], s96 offen offset:128 nt
    s_add_u32 s96, s77, 0x601000
    s_waitcnt vmcnt(7)
    s_cmp_gt_u32 s36, 1
    s_cbranch_scc1 L_th_26
    s_waitcnt vmcnt(6)
    s_cmp_gt_u32 s36, 0
    s_cbranch_scc1 L_th_26
    s_waitcnt vmcnt(4)
L_th_26:
    buffer_load_dwordx4 v[120:123], v3, s[44:47], s96 offen offset:512 nt
    s_add_u32 s96, s77, 0x601000
    s_waitcnt vmcnt(7)
    s_cmp_gt_u32 s36, 1
    s_cbranch_scc1 L_th_27
    s_waitcnt vmcnt(5)
    s_cmp_gt_u32 s36, 0
    s_cbranch_scc1 L_th_27
    s_waitcnt vmcnt(4)
L_th_27:
    buffer_load_dwordx4 v[124:127], v3, s[44:47], s96 offen offset:640 nt
    s_add_u32 s96, s77, 0x800000
    s_waitcnt vmcnt(7)
    s_cmp_gt_u32 s36, 1
    s_cbranch_scc1 L_th_28
    s_waitcnt vmcnt(6)
    s_cmp_gt_u32 s36, 0
    s_cbranch_scc1 L_th_28
    s_waitcnt vmcnt(4)
L_th_28:
    buffer_load_dwordx4 v[128:131], v3, s[44:47], s96 offen offset:0 nt
    s_add_u32 s96, s77, 0x800000
    s_waitcnt vmcnt(7)
    s_cmp_gt_u32 s36, 1
    s_cbranch_scc1 L_th_29
    s_waitcnt vmcnt(5)
    s_cmp_gt_u32 s36, 0
    s_cbranch_scc1 L_th_29
    s_waitcnt vmcnt(4)
L_th_29:
    buffer_load_dwordx4 v[132:135], v3, s[44:47], s96 offen offset:128 nt
    s_add_u32 s96, s77, 0x800000
    s_waitcnt vmcnt(7)
    s_cmp_gt_u32 s36, 1
    s_cbranch_scc1 L_th_30
    s_waitcnt vmcnt(6)
    s_cmp_gt_u32 s36, 0
    s_cbranch_scc1 L_th_30
    s_waitcnt vmcnt(4)
L_th_30:
    buffer_load_dwordx4 v[136:139], v3, s[44:47], s96 offen offset:512 nt
    s_add_u32 s96, s77, 0x800000
    s_waitcnt vmcnt(7)
    s_cmp_gt_u32 s36, 1
    s_cbranch_scc1 L_th_31
    s_waitcnt vmcnt(5)
    s_cmp_gt_u32 s36, 0
    s_cbranch_scc1 L_th_31
    s_waitcnt vmcnt(4)
L_th_31:
    buffer_load_dwordx4 v[140:143], v3, s[44:47], s96 offen offset:640 nt
    s_add_u32 s96, s77, 0x801000
    s_waitcnt vmcnt(7)
    s_cmp_gt_u32 s36, 1
    s_cbranch_scc1 L_th_32
    s_waitcnt vmcnt(6)
    s_cmp_gt_u32 s36, 0
    s_cbranch_scc1 L_th_32
    s_waitcnt vmcnt(4)
L_th_32:
    buffer_load_dwordx4 v[144:147], v3, s[44:47], s96 offen offset:0 nt
    s_add_u32 s96, s77, 0x801000
    s_waitcnt vmcnt(7)
    s_cmp_gt_u32 s36, 1
    s_cbranch_scc1 L_th_33
    s_waitcnt vmcnt(5)
    s_cmp_gt_u32 s36, 0
    s_cbranch_scc1 L_th_33
    s_waitcnt vmcnt(4)
L_th_33:
    buffer_load_dwordx4 v[148:151], v3, s[44:47], s96 offen offset:128 nt
    s_add_u32 s96, s77, 0x801000
    s_waitcnt vmcnt(7)
    s_cmp_gt_u32 s36, 1
    s_cbranch_scc1 L_th_34
    s_waitcnt vmcnt(6)
    s_cmp_gt_u32 s36, 0
    s_cbranch_scc1 L_th_34
    s_waitcnt vmcnt(4)
L_th_34:
    buffer_load_dwordx4 v[152:155], v3, s[44:47], s96 offen offset:512 nt
    s_add_u32 s96, s77, 0x801000
    s_waitcnt vmcnt(7)
    s_cmp_gt_u32 s36, 1
    s_cbranch_scc1 L_th_35
    s_waitcnt vmcnt(5)
    s_cmp_gt_u32 s36, 0
    s_cbranch_scc1 L_th_35
    s_waitcnt vmcnt(4)
L_th_35:
    buffer_load_dwordx4 v[156:159], v3, s[44:47], s96 offen offset:640 nt
    s_add_u32 s96, s77, 0xa00000
    s_waitcnt vmcnt(7)
    s_cmp_gt_u32 s36, 1
    s_cbranch_scc1 L_th_36
    s_waitcnt vmcnt(6)
    s_cmp_gt_u32 s36, 0
    s_cbranch_scc1 L_th_36
    s_waitcnt vmcnt(4)
L_th_36:
    buffer_load_dwordx4 v[160:163], v3, s[44:47], s96 offen offset:0 nt
    s_add_u32 s96, s77, 0xa00000
    s_waitcnt vmcnt(7)
    s_cmp_gt_u32 s36, 1
    s_cbranch_scc1 L_th_37
    s_waitcnt vmcnt(5)
    s_cmp_gt_u32 s36, 0
    s_cbranch_scc1 L_th_37
    s_waitcnt vmcnt(4)
L_th_37:
    buffer_load_dwordx4 v[164:167], v3, s[44:47], s96 offen offset:128 nt
    s_add_u32 s96, s77, 0xa00000
    s_waitcnt vmcnt(7)
    s_cmp_gt_u32 s36, 1
    s_cbranch_scc1 L_th_38
    s_waitcnt vmcnt(6)
    s_cmp_gt_u32 s36, 0
    s_cbranch_scc1 L_th_38
    s_waitcnt vmcnt(4)
L_th_38:
    buffer_load_dwordx4 v[168:171], v3, s[44:47], s96 offen offset:512 nt
    s_add_u32 s96, s77, 0xa00000
    s_waitcnt vmcnt(7)
    s_cmp_gt_u32 s36, 1
    s_cbranch_scc1 L_th_39
    s_waitcnt vmcnt(5)
    s_cmp_gt_u32 s36, 0
    s_cbranch_scc1 L_th_39
    s_waitcnt vmcnt(4)
L_th_39:
    buffer_load_dwordx4 v[172:175], v3, s[44:47], s96 offen offset:640 nt
    s_add_u32 s96, s77, 0xa01000
    s_waitcnt vmcnt(7)
    s_cmp_gt_u32 s36, 1
    s_cbranch_scc1 L_th_40
    s_waitcnt vmcnt(6)
    s_cmp_gt_u32 s36, 0
    s_cbranch_scc1 L_th_40
    s_waitcnt vmcnt(4)
L_th_40:
    buffer_load_dwordx4 v[176:179], v3, s[44:47], s96 offen offset:0 nt
    s_add_u32 s96, s77, 0xa01000
    s_waitcnt vmcnt(7)
    s_cmp_gt_u32 s36, 1
    s_cbranch_scc1 L_th_41
    s_waitcnt vmcnt(5)
    s_cmp_gt_u32 s36, 0
    s_cbranch_scc1 L_th_41
    s_waitcnt vmcnt(4)
L_th_41:
    buffer_load_dwordx4 v[180:183], v3, s[44:47], s96 offen offset:128 nt
    s_add_u32 s96, s77, 0xa01000
    s_waitcnt vmcnt(7)
    s_cmp_gt_u32 s36, 1
    s_cbranch_scc1 L_th_42
    s_waitcnt vmcnt(6)
    s_cmp_gt_u32 s36, 0
    s_cbranch_scc1 L_th_42
    s_waitcnt vmcnt(4)
L_th_42:
    buffer_load_dwordx4 v[184:187], v3, s[44:47], s96 offen offset:512 nt
    s_add_u32 s96, s77, 0xa01000
    s_waitcnt vmcnt(7)
    s_cmp_gt_u32 s36, 1
    s_cbranch_scc1 L_th_43
    s_waitcnt vmcnt(5)
    s_cmp_gt_u32 s36, 0
    s_cbranch_scc1 L_th_43
    s_waitcnt vmcnt(4)
L_th_43:
    buffer_load_dwordx4 v[188:191], v3, s[44:47], s96 offen offset:640 nt
    v_mov_b32 v9, 1
    s_mov_b64 exec, 1
    ds_add_u32 v7, v9 offset:32
    s_mov_b64 exec, -1
    s_add_u32 s96, s77, 0xc00000
    s_waitcnt vmcnt(7)
    s_cmp_gt_u32 s36, 1
    s_cbranch_scc1 L_th_44
    s_waitcnt vmcnt(6)
    s_cmp_gt_u32 s36, 0
    s_cbranch_scc1 L_th_44
    s_waitcnt vmcnt(4)
L_th_44:
    buffer_load_dwordx4 v[192:195], v3, s[44:47], s96 offen offset:0 nt
    s_add_u32 s96, s77, 0xc00000
    s_waitcnt vmcnt(7)
    s_cmp_gt_u32 s36, 1
    s_cbranch_scc1 L_th_45
    s_waitcnt vmcnt(5)
    s_cmp_gt_u32 s36, 0
    s_cbranch_scc1 L_th_45
    s_waitcnt vmcnt(4)
L_th_45:
    buffer_load_dwordx4 v[196:199], v3, s[44:47], s96 offen offset:128 nt
    s_add_u32 s96, s77, 0xc00000
    s_waitcnt vmcnt(7)
    s_cmp_gt_u32 s36, 1
    s_cbranch_scc1 L_th_46
    s_waitcnt vmcnt(6)
    s_cmp_gt_u32 s36, 0
    s_cbranch_scc1 L_th_46
    s_waitcnt vmcnt(4)
L_th_46:
    buffer_load_dwordx4 v[200:203], v3, s[44:47], s96 offen offset:512 nt
    s_add_u32 s96, s77, 0xc00000
    s_waitcnt vmcnt(7)
    s_cmp_gt_u32 s36, 1
    s_cbranch_scc1 L_th_47
    s_waitcnt vmcnt(5)
    s_cmp_gt_u32 s36, 0
    s_cbranch_scc1 L_th_47
    s_waitcnt vmcnt(4)
L_th_47:
    buffer_load_dwordx4 v[204:207], v3, s[44:47], s96 offen offset:640 nt
    s_add_u32 s96, s77, 0xc01000
    s_waitcnt vmcnt(7)
    s_cmp_gt_u32 s36, 1
    s_cbranch_scc1 L_th_48
    s_waitcnt vmcnt(6)
    s_cmp_gt_u32 s36, 0
    s_cbranch_scc1 L_th_48
    s_waitcnt vmcnt(4)
L_th_48:
    buffer_load_dwordx4 v[208:211], v3, s[44:47], s96 offen offset:0 nt
    s_add_u32 s96, s77, 0xc01000
    s_waitcnt vmcnt(7)
    s_cmp_gt_u32 s36, 1
    s_cbranch_scc1 L_th_49
    s_waitcnt vmcnt(5)
    s_cmp_gt_u32 s36, 0
    s_cbranch_scc1 L_th_49
    s_waitcnt vmcnt(4)
L_th_49:
    buffer_load_dwordx4 v[212:215], v3, s[44:47], s96 offen offset:128 nt
    s_add_u32 s96, s77, 0xc01000
    s_waitcnt vmcnt(7)
    s_cmp_gt_u32 s36, 1
    s_cbranch_scc1 L_th_50
    s_waitcnt vmcnt(6)
    s_cmp_gt_u32 s36, 0
    s_cbranch_scc1 L_th_50
    s_waitcnt vmcnt(4)
L_th_50:
    buffer_load_dwordx4 v[216:219], v3, s[44:47], s96 offen offset:512 nt
    s_add_u32 s96, s77, 0xc01000
    s_waitcnt vmcnt(7)
    s_cmp_gt_u32 s36, 1
    s_cbranch_scc1 L_th_51
    s_waitcnt vmcnt(5)
    s_cmp_gt_u32 s36, 0
    s_cbranch_scc1 L_th_51
    s_waitcnt vmcnt(4)
L_th_51:
    buffer_load_dwordx4 v[220:223], v3, s[44:47], s96 offen offset:640 nt
    s_add_u32 s96, s77, 0xe00000
    s_waitcnt vmcnt(7)
    s_cmp_gt_u32 s36, 1
    s_cbranch_scc1 L_th_52
    s_waitcnt vmcnt(6)
    s_cmp_gt_u32 s36, 0
    s_cbranch_scc1 L_th_52
    s_waitcnt vmcnt(4)
L_th_52:
    buffer_load_dwordx4 v[224:227], v3, s[44:47], s96 offen offset:0 nt
    s_add_u32 s96, s77, 0xe00000
    s_waitcnt vmcnt(7)
    s_cmp_gt_u32 s36, 1
    s_cbranch_scc1 L_th_53
    s_waitcnt vmcnt(5)
    s_cmp_gt_u32 s36, 0
    s_cbranch_scc1 L_th_53
    s_waitcnt vmcnt(4)
L_th_53:
    buffer_load_dwordx4 v[228:231], v3, s[44:47], s96 offen offset:128 nt
    s_add_u32 s96, s77, 0xe00000
    s_waitcnt vmcnt(7)
    s_cmp_gt_u32 s36, 1
    s_cbranch_scc1 L_th_54
    s_waitcnt vmcnt(6)
    s_cmp_gt_u32 s36, 0
    s_cbranch_scc1 L_th_54
    s_waitcnt vmcnt(4)
L_th_54:
    buffer_load_dwordx4 v[232:235], v3, s[44:47], s96 offen offset:512 nt
    s_add_u32 s96, s77, 0xe00000
    s_waitcnt vmcnt(7)
    s_cmp_gt_u32 s36, 1
    s_cbranch_scc1 L_th_55
    s_waitcnt vmcnt(5)
    s_cmp_gt_u32 s36, 0
    s_cbranch_scc1 L_th_55
    s_waitcnt vmcnt(4)
L_th_55:
    buffer_load_dwordx4 v[236:239], v3, s[44:47], s96 offen offset:640 nt
    s_add_u32 s96, s77, 0xe01000
    s_waitcnt vmcnt(7)
    s_cmp_gt_u32 s36, 1
    s_cbranch_scc1 L_th_56
    s_waitcnt vmcnt(6)
    s_cmp_gt_u32 s36, 0
    s_cbranch_scc1 L_th_56
    s_waitcnt vmcnt(4)
L_th_56:
    buffer_load_dwordx4 v[240:243], v3, s[44:47], s96 offen offset:0 nt
    s_add_u32 s96, s77, 0xe01000
    s_waitcnt vmcnt(7)
    s_cmp_gt_u32 s36, 1
    s_cbranch_scc1 L_th_57
    s_waitcnt vmcnt(5)
    s_cmp_gt_u32 s36, 0
    s_cbranch_scc1 L_th_57
    s_waitcnt vmcnt(4)
L_th_57:
    buffer_load_dwordx4 v[244:247], v3, s[44:47], s96 offen offset:128 nt
    s_add_u32 s96, s77, 0xe01000
    s_waitcnt vmcnt(7)
    s_cmp_gt_u32 s36, 1
    s_cbranch_scc1 L_th_58
    s_waitcnt vmcnt(6)
    s_cmp_gt_u32 s36, 0
    s_cbranch_scc1 L_th_58
    s_waitcnt vmcnt(4)
L_th_58:
    buffer_load_dwordx4 v[248:251], v3, s[44:47], s96 offen offset:512 nt
    s_add_u32 s96, s77, 0xe01000
    s_waitcnt vmcnt(7)
    s_cmp_gt_u32 s36, 1
    s_cbranch_scc1 L_th_59
    s_waitcnt vmcnt(5)
    s_cmp_gt_u32 s36, 0
    s_cbranch_scc1 L_th_59
    s_waitcnt vmcnt(4)
L_th_59:
    buffer_load_dwordx4 v[252:255], v3, s[44:47], s96 offen offset:640 nt
L_ldsw_60:
    ds_read_b32 v8, v7 offset:4
    s_waitcnt lgkmcnt(0)
    v_readfirstlane_b32 s96, v8
    s_nop 0
    s_cmp_ge_u32 s96, 1
    s_nop 1
    s_cbranch_scc1 L_ldsd_61
    s_sleep 2
    s_sub_u32 s76, s76, 1
    s_cmp_lg_u32 s76, 0
    s_cbranch_scc1 L_ldsw_60
    s_branch L_end
L_ldsd_61:
    v_and_b32 v8, 7, v1
    v_mul_u32_u24 v8, 272, v8
    v_lshl_add_u32 v8, v2, 4, v8
    v_lshrrev_b32 v9, 3, v1
    v_lshl_add_u32 v8, v9, 6, v8
    ds_read_b128 v[16:19], v8 offset:512
    ds_read_b128 v[20:23], v8 offset:640
    v_add_u32 v5, s65, v4
    s_waitcnt lgkmcnt(0)
    ds_read_b128 v[64:67], v5 offset:0
    ds_read_b128 v[68:71], v5 offset:1024
    ds_read_b128 v[72:75], v5 offset:2048
    ds_read_b128 v[76:79], v5 offset:3072
    ds_read_b128 v[80:83], v5 offset:4096
    ds_read_b128 v[84:87], v5 offset:5120
    ds_read_b128 v[88:91], v5 offset:6144
    ds_read_b128 v[92:95], v5 offset:7168
    s_waitcnt lgkmcnt(0)
    v_mfma_f32_16x16x32_bf16 v[32:35], v[64:67], v[16:19], 0
    v_mfma_f32_16x16x32_bf16 v[24:27], v[72:75], v[16:19], 0
    v_mfma_f32_16x16x32_bf16 v[32:35], v[68:71], v[20:23], v[32:35]
    v_mfma_f32_16x16x32_bf16 v[24:27], v[76:79], v[20:23], v[24:27]
    v_mfma_f32_16x16x32_bf16 v[36:39], v[80:83], v[16:19], 0
    v_mfma_f32_16x16x32_bf16 v[28:31], v[88:91], v[16:19], 0
    v_mfma_f32_16x16x32_bf16 v[36:39], v[84:87], v[20:23], v[36:39]
    v_mfma_f32_16x16x32_bf16 v[28:31], v[92:95], v[20:23], v[28:31]
    s_nop 3
    v_permlane32_swap_b32 v32, v24
    v_permlane32_swap_b32 v33, v25
    v_permlane32_swap_b32 v34, v26
    v_permlane32_swap_b32 v35, v27
    v_add_f32_dpp v32, v24, v32 row_ror:8 row_mask:0xf bank_mask:0xf
    v_add_f32_dpp v33, v25, v33 row_ror:8 row_mask:0xf bank_mask:0xf
    v_add_f32_dpp v34, v26, v34 row_ror:8 row_mask:0xf bank_mask:0xf
    v_add_f32_dpp v35, v27, v35 row_ror:8 row_mask:0xf bank_mask:0xf
    v_cvt_pk_bf16_f32 v33, v32, v33
    v_lshlrev_b32 v32, 16, v33
    v_and_b32 v33, s15, v33
    v_mul_f32 v32, s64, v32
    v_mul_f32 v33, s64, v33
    v_cvt_pk_bf16_f32 v33, v32, v33
    v_lshlrev_b32 v32, 16, v33
    v_and_b32 v33, s15, v33
    v_cvt_pk_bf16_f32 v35, v34, v35
    v_lshlrev_b32 v34, 16, v35
    v_and_b32 v35, s15, v35
    v_mul_f32 v34, s64, v34
    v_mul_f32 v35, s64, v35
    v_cvt_pk_bf16_f32 v35, v34, v35
    v_lshlrev_b32 v34, 16, v35
    v_and_b32 v35, s15, v35
    s_add_u32 s96, s77, 0x0
    s_add_u32 m0, s65, 0x0
    s_nop 0
    buffer_load_dwordx4 v4, s[48:51], s96 offen nt lds
    s_add_u32 s96, s77, 0x400
    s_add_u32 m0, s65, 0x400
    s_nop 0
    buffer_load_dwordx4 v4, s[48:51], s96 offen nt lds
    ds_read_b128 v[64:67], v5 offset:8192
    ds_read_b128 v[68:71], v5 offset:9216
    ds_read_b128 v[72:75], v5 offset:10240
    ds_read_b128 v[76:79], v5 offset:11264
    ds_read_b128 v[80:83], v5 offset:12288
    ds_read_b128 v[84:87], v5 offset:13312
    ds_read_b128 v[88:91], v5 offset:14336
    ds_read_b128 v[92:95], v5 offset:15360
    s_waitcnt lgkmcnt(0)
    v_mfma_f32_16x16x32_bf16 v[40:43], v[64:67], v[16:19], 0
    v_mfma_f32_16x16x32_bf16 v[24:27], v[72:75], v[16:19], 0
    v_mfma_f32_16x16x32_bf16 v[40:43], v[68:71], v[20:23], v[40:43]
    v_mfma_f32_16x16x32_bf16 v[24:27], v[76:79], v[20:23], v[24:27]
    v_permlane32_swap_b32 v36, v28
    v_permlane32_swap_b32 v37, v29
    v_permlane32_swap_b32 v38, v30
    v_permlane32_swap_b32 v39, v31
    v_add_f32_dpp v36, v28, v36 row_ror:8 row_mask:0xf bank_mask:0xf
    v_add_f32_dpp v37, v29, v37 row_ror:8 row_mask:0xf bank_mask:0xf
    v_add_f32_dpp v38, v30, v38 row_ror:8 row_mask:0xf bank_mask:0xf
    v_add_f32_dpp v39, v31, v39 row_ror:8 row_mask:0xf bank_mask:0xf
    v_cvt_pk_bf16_f32 v37, v36, v37
    v_lshlrev_b32 v36, 16, v37
    v_and_b32 v37, s15, v37
    v_mul_f32 v36, s64, v36
    v_mul_f32 v37, s64, v37
    v_cvt_pk_bf16_f32 v37, v36, v37
    v_lshlrev_b32 v36, 16, v37
    v_and_b32 v37, s15, v37
    v_cvt_pk_bf16_f32 v39, v38, v39
    v_lshlrev_b32 v38, 16, v39
    v_and_b32 v39, s15, v39
    v_mul_f32 v38, s64, v38
    v_mul_f32 v39, s64, v39
    v_cvt_pk_bf16_f32 v39, v38, v39
    v_lshlrev_b32 v38, 16, v39
    v_and_b32 v39, s15, v39
    v_mfma_f32_16x16x32_bf16 v[44:47], v[80:83], v[16:19], 0
    v_mfma_f32_16x16x32_bf16 v[28:31], v[88:91], v[16:19], 0
    v_mfma_f32_16x16x32_bf16 v[44:47], v[84:87], v[20:23], v[44:47]
    v_mfma_f32_16x16x32_bf16 v[28:31], v[92:95], v[20:23], v[28:31]
    v_permlane32_swap_b32 v40, v24
    v_permlane32_swap_b32 v41, v25
    v_permlane32_swap_b32 v42, v26
    v_permlane32_swap_b32 v43, v27
    v_add_f32_dpp v40, v24, v40 row_ror:8 row_mask:0xf bank_mask:0xf
    v_add_f32_dpp v41, v25, v41 row_ror:8 row_mask:0xf bank_mask:0xf
    v_add_f32_dpp v42, v26, v42 row_ror:8 row_mask:0xf bank_mask:0xf
    v_add_f32_dpp v43, v27, v43 row_ror:8 row_mask:0xf bank_mask:0xf
    v_cvt_pk_bf16_f32 v41, v40, v41
    v_lshlrev_b32 v40, 16, v41
    v_and_b32 v41, s15, v41
    v_mul_f32 v40, s64, v40
    v_mul_f32 v41, s64, v41
    v_cvt_pk_bf16_f32 v41, v40, v41
    v_lshlrev_b32 v40, 16, v41
    v_and_b32 v41, s15, v41
    v_cvt_pk_bf16_f32 v43, v42, v43
    v_lshlrev_b32 v42, 16, v43
    v_and_b32 v43, s15, v43
    v_mul_f32 v42, s64, v42
    v_mul_f32 v43, s64, v43
    v_cvt_pk_bf16_f32 v43, v42, v43
    v_lshlrev_b32 v42, 16, v43
    v_and_b32 v43, s15, v43
    s_add_u32 s96, s77, 0x800
    s_add_u32 m0, s65, 0x800
    s_nop 0
    buffer_load_dwordx4 v4, s[48:51], s96 offen nt lds
    s_add_u32 s96, s77, 0xc00
    s_add_u32 m0, s65, 0xc00
    s_nop 0
    buffer_load_dwordx4 v4, s[48:51], s96 offen nt lds
    ds_read_b128 v[64:67], v5 offset:16384
    ds_read_b128 v[68:71], v5 offset:17408
    ds_read_b128 v[72:75], v5 offset:18432
    ds_read_b128 v[76:79], v5 offset:19456
    ds_read_b128 v[80:83], v5 offset:20480
    ds_read_b128 v[84:87], v5 offset:21504
    ds_read_b128 v[88:91], v5 offset:22528
    ds_read_b128 v[92:95], v5 offset:23552
    s_waitcnt lgkmcnt(0)
    v_mfma_f32_16x16x32_bf16 v[48:51], v[64:67], v[16:19], 0
    v_mfma_f32_16x16x32_bf16 v[24:27], v[72:75], v[16:19], 0
    v_mfma_f32_16x16x32_bf16 v[48:51], v[68:71], v[20:23], v[48:51]
    v_mfma_f32_16x16x32_bf16 v[24:27], v[76:79], v[20:23], v[24:27]
    v_permlane32_swap_b32 v44, v28
    v_permlane32_swap_b32 v45, v29
    v_permlane32_swap_b32 v46, v30
    v_permlane32_swap_b32 v47, v31
    v_add_f32_dpp v44, v28, v44 row_ror:8 row_mask:0xf bank_mask:0xf
    v_add_f32_dpp v45, v29, v45 row_ror:8 row_mask:0xf bank_mask:0xf
    v_add_f32_dpp v46, v30, v46 row_ror:8 row_mask:0xf bank_mask:0xf
    v_add_f32_dpp v47, v31, v47 row_ror:8 row_mask:0xf bank_mask:0xf
    v_cvt_pk_bf16_f32 v45, v44, v45
    v_lshlrev_b32 v44, 16, v45
    v_and_b32 v45, s15, v45
    v_mul_f32 v44, s64, v44
    v_mul_f32 v45, s64, v45
    v_cvt_pk_bf16_f32 v45, v44, v45
    v_lshlrev_b32 v44, 16, v45
    v_and_b32 v45, s15, v45
    v_cvt_pk_bf16_f32 v47, v46, v47
    v_lshlrev_b32 v46, 16, v47
    v_and_b32 v47, s15, v47
    v_mul_f32 v46, s64, v46
    v_mul_f32 v47, s64, v47
    v_cvt_pk_bf16_f32 v47, v46, v47
    v_lshlrev_b32 v46, 16, v47
    v_and_b32 v47, s15, v47
    v_mfma_f32_16x16x32_bf16 v[52:55], v[80:83], v[16:19], 0
    v_mfma_f32_16x16x32_bf16 v[28:31], v[88:91], v[16:19], 0
    v_mfma_f32_16x16x32_bf16 v[52:55], v[84:87], v[20:23], v[52:55]
    v_mfma_f32_16x16x32_bf16 v[28:31], v[92:95], v[20:23], v[28:31]
    v_permlane32_swap_b32 v48, v24
    v_permlane32_swap_b32 v49, v25
    v_permlane32_swap_b32 v50, v26
    v_permlane32_swap_b32 v51, v27
    v_add_f32_dpp v48, v24, v48 row_ror:8 row_mask:0xf bank_mask:0xf
    v_add_f32_dpp v49, v25, v49 row_ror:8 row_mask:0xf bank_mask:0xf
    v_add_f32_dpp v50, v26, v50 row_ror:8 row_mask:0xf bank_mask:0xf
    v_add_f32_dpp v51, v27, v51 row_ror:8 row_mask:0xf bank_mask:0xf
    v_cvt_pk_bf16_f32 v49, v48, v49
    v_lshlrev_b32 v48, 16, v49
    v_and_b32 v49, s15, v49
    v_mul_f32 v48, s64, v48
    v_mul_f32 v49, s64, v49
    v_cvt_pk_bf16_f32 v49, v48, v49
    v_lshlrev_b32 v48, 16, v49
    v_and_b32 v49, s15, v49
    v_cvt_pk_bf16_f32 v51, v50, v51
    v_lshlrev_b32 v50, 16, v51
    v_and_b32 v51, s15, v51
    v_mul_f32 v50, s64, v50
    v_mul_f32 v51, s64, v51
    v_cvt_pk_bf16_f32 v51, v50, v51
    v_lshlrev_b32 v50, 16, v51
    v_and_b32 v51, s15, v51
    s_add_u32 s96, s77, 0x1000
    s_add_u32 m0, s65, 0x1000
    s_nop 0
    buffer_load_dwordx4 v4, s[48:51], s96 offen nt lds
    s_add_u32 s96, s77, 0x1400
    s_add_u32 m0, s65, 0x1400
    s_nop 0
    buffer_load_dwordx4 v4, s[48:51], s96 offen nt lds
    v_mfma_f32_16x16x32_bf16 v[56:59], v[96:99], v[16:19], 0
    v_mfma_f32_16x16x32_bf16 v[24:27], v[104:107], v[16:19], 0
    v_mfma_f32_16x16x32_bf16 v[56:59], v[100:103], v[20:23], v[56:59]
    v_mfma_f32_16x16x32_bf16 v[24:27], v[108:111], v[20:23], v[24:27]
    v_permlane32_swap_b32 v52, v28
    v_permlane32_swap_b32 v53, v29
    v_permlane32_swap_b32 v54, v30
    v_permlane32_swap_b32 v55, v31
    v_add_f32_dpp v52, v28, v52 row_ror:8 row_mask:0xf bank_mask:0xf
    v_add_f32_dpp v53, v29, v53 row_ror:8 row_mask:0xf bank_mask:0xf
    v_add_f32_dpp v54, v30, v54 row_ror:8 row_mask:0xf bank_mask:0xf
    v_add_f32_dpp v55, v31, v55 row_ror:8 row_mask:0xf bank_mask:0xf
    v_cvt_pk_bf16_f32 v53, v52, v53
    v_lshlrev_b32 v52, 16, v53
    v_and_b32 v53, s15, v53
    v_mul_f32 v52, s64, v52
    v_mul_f32 v53, s64, v53
    v_cvt_pk_bf16_f32 v53, v52, v53
    v_lshlrev_b32 v52, 16, v53
    v_and_b32 v53, s15, v53
    v_cvt_pk_bf16_f32 v55, v54, v55
    v_lshlrev_b32 v54, 16, v55
    v_and_b32 v55, s15, v55
    v_mul_f32 v54, s64, v54
    v_mul_f32 v55, s64, v55
    v_cvt_pk_bf16_f32 v55, v54, v55
    v_lshlrev_b32 v54, 16, v55
    v_and_b32 v55, s15, v55
    v_mfma_f32_16x16x32_bf16 v[60:63], v[112:115], v[16:19], 0
    v_mfma_f32_16x16x32_bf16 v[28:31], v[120:123], v[16:19], 0
    v_mfma_f32_16x16x32_bf16 v[60:63], v[116:119], v[20:23], v[60:63]
    v_mfma_f32_16x16x32_bf16 v[28:31], v[124:127], v[20:23], v[28:31]
    v_permlane32_swap_b32 v56, v24
    v_permlane32_swap_b32 v57, v25
    v_permlane32_swap_b32 v58, v26
    v_permlane32_swap_b32 v59, v27
    v_add_f32_dpp v56, v24, v56 row_ror:8 row_mask:0xf bank_mask:0xf
    v_add_f32_dpp v57, v25, v57 row_ror:8 row_mask:0xf bank_mask:0xf
    v_add_f32_dpp v58, v26, v58 row_ror:8 row_mask:0xf bank_mask:0xf
    v_add_f32_dpp v59, v27, v59 row_ror:8 row_mask:0xf bank_mask:0xf
    v_cvt_pk_bf16_f32 v57, v56, v57
    v_lshlrev_b32 v56, 16, v57
    v_and_b32 v57, s15, v57
    v_mul_f32 v56, s64, v56
    v_mul_f32 v57, s64, v57
    v_cvt_pk_bf16_f32 v57, v56, v57
    v_lshlrev_b32 v56, 16, v57
    v_and_b32 v57, s15, v57
    v_cvt_pk_bf16_f32 v59, v58, v59
    v_lshlrev_b32 v58, 16, v59
    v_and_b32 v59, s15, v59
    v_mul_f32 v58, s64, v58
    v_mul_f32 v59, s64, v59
    v_cvt_pk_bf16_f32 v59, v58, v59
    v_lshlrev_b32 v58, 16, v59
    v_and_b32 v59, s15, v59
    s_add_u32 s96, s77, 0x1800
    s_add_u32 m0, s65, 0x1800
    s_nop 0
    buffer_load_dwordx4 v4, s[48:51], s96 offen nt lds
    s_add_u32 s96, s77, 0x1c00
    s_add_u32 m0, s65, 0x1c00
    s_nop 0
    buffer_load_dwordx4 v4, s[48:51], s96 offen nt lds
    v_mfma_f32_16x16x32_bf16 v[64:67], v[128:131], v[16:19], 0
    v_mfma_f32_16x16x32_bf16 v[24:27], v[136:139], v[16:19], 0
    v_mfma_f32_16x16x32_bf16 v[64:67], v[132:135], v[20:23], v[64:67]
    v_mfma_f32_16x16x32_bf16 v[24:27], v[140:143], v[20:23], v[24:27]
    v_permlane32_swap_b32 v60, v28
    v_permlane32_swap_b32 v61, v29
    v_permlane32_swap_b32 v62, v30
    v_permlane32_swap_b32 v63, v31
    v_add_f32_dpp v60, v28, v60 row_ror:8 row_mask:0xf bank_mask:0xf
    v_add_f32_dpp v61, v29, v61 row_ror:8 row_mask:0xf bank_mask:0xf
    v_add_f32_dpp v62, v30, v62 row_ror:8 row_mask:0xf bank_mask:0xf
    v_add_f32_dpp v63, v31, v63 row_ror:8 row_mask:0xf bank_mask:0xf
    v_cvt_pk_bf16_f32 v61, v60, v61
    v_lshlrev_b32 v60, 16, v61
    v_and_b32 v61, s15, v61
    v_mul_f32 v60, s64, v60
    v_mul_f32 v61, s64, v61
    v_cvt_pk_bf16_f32 v61, v60, v61
    v_lshlrev_b32 v60, 16, v61
    v_and_b32 v61, s15, v61
    v_cvt_pk_bf16_f32 v63, v62, v63
    v_lshlrev_b32 v62, 16, v63
    v_and_b32 v63, s15, v63
    v_mul_f32 v62, s64, v62
    v_mul_f32 v63, s64, v63
    v_cvt_pk_bf16_f32 v63, v62, v63
    v_lshlrev_b32 v62, 16, v63
    v_and_b32 v63, s15, v63
    v_mfma_f32_16x16x32_bf16 v[68:71], v[144:147], v[16:19], 0
    v_mfma_f32_16x16x32_bf16 v[28:31], v[152:155], v[16:19], 0
    v_mfma_f32_16x16x32_bf16 v[68:71], v[148:151], v[20:23], v[68:71]
    v_mfma_f32_16x16x32_bf16 v[28:31], v[156:159], v[20:23], v[28:31]
    v_permlane32_swap_b32 v64, v24
    v_permlane32_swap_b32 v65, v25
    v_permlane32_swap_b32 v66, v26
    v_permlane32_swap_b32 v67, v27
    v_add_f32_dpp v64, v24, v64 row_ror:8 row_mask:0xf bank_mask:0xf
    v_add_f32_dpp v65, v25, v65 row_ror:8 row_mask:0xf bank_mask:0xf
    v_add_f32_dpp v66, v26, v66 row_ror:8 row_mask:0xf bank_mask:0xf
    v_add_f32_dpp v67, v27, v67 row_ror:8 row_mask:0xf bank_mask:0xf
    v_cvt_pk_bf16_f32 v65, v64, v65
    v_lshlrev_b32 v64, 16, v65
    v_and_b32 v65, s15, v65
    v_mul_f32 v64, s64, v64
    v_mul_f32 v65, s64, v65
    v_cvt_pk_bf16_f32 v65, v64, v65
    v_lshlrev_b32 v64, 16, v65
    v_and_b32 v65, s15, v65
    v_cvt_pk_bf16_f32 v67, v66, v67
    v_lshlrev_b32 v66, 16, v67
    v_and_b32 v67, s15, v67
    v_mul_f32 v66, s64, v66
    v_mul_f32 v67, s64, v67
    v_cvt_pk_bf16_f32 v67, v66, v67
    v_lshlrev_b32 v66, 16, v67
    v_and_b32 v67, s15, v67
    s_add_u32 s96, s77, 0x200000
    s_add_u32 m0, s65, 0x2000
    s_nop 0
    buffer_load_dwordx4 v4, s[48:51], s96 offen nt lds
    s_add_u32 s96, s77, 0x200400
    s_add_u32 m0, s65, 0x2400
    s_nop 0
    buffer_load_dwordx4 v4, s[48:51], s96 offen nt lds
    v_mfma_f32_16x16x32_bf16 v[72:75], v[160:163], v[16:19], 0
    v_mfma_f32_16x16x32_bf16 v[24:27], v[168:171], v[16:19], 0
    v_mfma_f32_16x16x32_bf16 v[72:75], v[164:167], v[20:23], v[72:75]
    v_mfma_f32_16x16x32_bf16 v[24:27], v[172:175], v[20:23], v[24:27]
    v_permlane32_swap_b32 v68, v28
    v_permlane32_swap_b32 v69, v29
    v_permlane32_swap_b32 v70, v30
    v_permlane32_swap_b32 v71, v31
    v_add_f32_dpp v68, v28, v68 row_ror:8 row_mask:0xf bank_mask:0xf
    v_add_f32_dpp v69, v29, v69 row_ror:8 row_mask:0xf bank_mask:0xf
    v_add_f32_dpp v70, v30, v70 row_ror:8 row_mask:0xf bank_mask:0xf
    v_add_f32_dpp v71, v31, v71 row_ror:8 row_mask:0xf bank_mask:0xf
    v_cvt_pk_bf16_f32 v69, v68, v69
    v_lshlrev_b32 v68, 16, v69
    v_and_b32 v69, s15, v69
    v_mul_f32 v68, s64, v68
    v_mul_f32 v69, s64, v69
    v_cvt_pk_bf16_f32 v69, v68, v69
    v_lshlrev_b32 v68, 16, v69
    v_and_b32 v69, s15, v69
    v_cvt_pk_bf16_f32 v71, v70, v71
    v_lshlrev_b32 v70, 16, v71
    v_and_b32 v71, s15, v71
    v_mul_f32 v70, s64, v70
    v_mul_f32 v71, s64, v71
    v_cvt_pk_bf16_f32 v71, v70, v71
    v_lshlrev_b32 v70, 16, v71
    v_and_b32 v71, s15, v71
    v_mfma_f32_16x16x32_bf16 v[76:79], v[176:179], v[16:19], 0
    v_mfma_f32_16x16x32_bf16 v[28:31], v[184:187], v[16:19], 0
    v_mfma_f32_16x16x32_bf16 v[76:79], v[180:183], v[20:23], v[76:79]
    v_mfma_f32_16x16x32_bf16 v[28:31], v[188:191], v[20:23], v[28:31]
    v_permlane32_swap_b32 v72, v24
    v_permlane32_swap_b32 v73, v25
    v_permlane32_swap_b32 v74, v26
    v_permlane32_swap_b32 v75, v27
    v_add_f32_dpp v72, v24, v72 row_ror:8 row_mask:0xf bank_mask:0xf
    v_add_f32_dpp v73, v25, v73 row_ror:8 row_mask:0xf bank_mask:0xf
    v_add_f32_dpp v74, v26, v74 row_ror:8 row_mask:0xf bank_mask:0xf
    v_add_f32_dpp v75, v27, v75 row_ror:8 row_mask:0xf bank_mask:0xf
    v_cvt_pk_bf16_f32 v73, v72, v73
    v_lshlrev_b32 v72, 16, v73
    v_and_b32 v73, s15, v73
    v_mul_f32 v72, s64, v72
    v_mul_f32 v73, s64, v73
    v_cvt_pk_bf16_f32 v73, v72, v73
    v_lshlrev_b32 v72, 16, v73
    v_and_b32 v73, s15, v73
    v_cvt_pk_bf16_f32 v75, v74, v75
    v_lshlrev_b32 v74, 16, v75
    v_and_b32 v75, s15, v75
    v_mul_f32 v74, s64, v74
    v_mul_f32 v75, s64, v75
    v_cvt_pk_bf16_f32 v75, v74, v75
    v_lshlrev_b32 v74, 16, v75
    v_and_b32 v75, s15, v75
    s_add_u32 s96, s77, 0x200800
    s_add_u32 m0, s65, 0x2800
    s_nop 0
    buffer_load_dwordx4 v4, s[48:51], s96 offen nt lds
    s_add_u32 s96, s77, 0x200c00
    s_add_u32 m0, s65, 0x2c00
    s_nop 0
    buffer_load_dwordx4 v4, s[48:51], s96 offen nt lds
    v_mfma_f32_16x16x32_bf16 v[80:83], v[192:195], v[16:19], 0
    v_mfma_f32_16x16x32_bf16 v[24:27], v[200:203], v[16:19], 0
    v_mfma_f32_16x16x32_bf16 v[80:83], v[196:199], v[20:23], v[80:83]
    v_mfma_f32_16x16x32_bf16 v[24:27], v[204:207], v[20:23], v[24:27]
    v_permlane32_swap_b32 v76, v28
    v_permlane32_swap_b32 v77, v29
    v_permlane32_swap_b32 v78, v30
    v_permlane32_swap_b32 v79, v31
    v_add_f32_dpp v76, v28, v76 row_ror:8 row_mask:0xf bank_mask:0xf
    v_add_f32_dpp v77, v29, v77 row_ror:8 row_mask:0xf bank_mask:0xf
    v_add_f32_dpp v78, v30, v78 row_ror:8 row_mask:0xf bank_mask:0xf
    v_add_f32_dpp v79, v31, v79 row_ror:8 row_mask:0xf bank_mask:0xf
    v_cvt_pk_bf16_f32 v77, v76, v77
    v_lshlrev_b32 v76, 16, v77
    v_and_b32 v77, s15, v77
    v_mul_f32 v76, s64, v76
    v_mul_f32 v77, s64, v77
    v_cvt_pk_bf16_f32 v77, v76, v77
    v_lshlrev_b32 v76, 16, v77
    v_and_b32 v77, s15, v77
    v_cvt_pk_bf16_f32 v79, v78, v79
    v_lshlrev_b32 v78, 16, v79
    v_and_b32 v79, s15, v79
    v_mul_f32 v78, s64, v78
    v_mul_f32 v79, s64, v79
    v_cvt_pk_bf16_f32 v79, v78, v79
    v_lshlrev_b32 v78, 16, v79
    v_and_b32 v79, s15, v79
    v_mfma_f32_16x16x32_bf16 v[84:87], v[208:211], v[16:19], 0
    v_mfma_f32_16x16x32_bf16 v[28:31], v[216:219], v[16:19], 0
    v_mfma_f32_16x16x32_bf16 v[84:87], v[212:215], v[20:23], v[84:87]
    v_mfma_f32_16x16x32_bf16 v[28:31], v[220:223], v[20:23], v[28:31]
    v_permlane32_swap_b32 v80, v24
    v_permlane32_swap_b32 v81, v25
    v_permlane32_swap_b32 v82, v26
    v_permlane32_swap_b32 v83, v27
    v_add_f32_dpp v80, v24, v80 row_ror:8 row_mask:0xf bank_mask:0xf
    v_add_f32_dpp v81, v25, v81 row_ror:8 row_mask:0xf bank_mask:0xf
    v_add_f32_dpp v82, v26, v82 row_ror:8 row_mask:0xf bank_mask:0xf
    v_add_f32_dpp v83, v27, v83 row_ror:8 row_mask:0xf bank_mask:0xf
    v_cvt_pk_bf16_f32 v81, v80, v81
    v_lshlrev_b32 v80, 16, v81
    v_and_b32 v81, s15, v81
    v_mul_f32 v80, s64, v80
    v_mul_f32 v81, s64, v81
    v_cvt_pk_bf16_f32 v81, v80, v81
    v_lshlrev_b32 v80, 16, v81
    v_and_b32 v81, s15, v81
    v_cvt_pk_bf16_f32 v83, v82, v83
    v_lshlrev_b32 v82, 16, v83
    v_and_b32 v83, s15, v83
    v_mul_f32 v82, s64, v82
    v_mul_f32 v83, s64, v83
    v_cvt_pk_bf16_f32 v83, v82, v83
    v_lshlrev_b32 v82, 16, v83
    v_and_b32 v83, s15, v83
    s_add_u32 s96, s77, 0x201000
    s_add_u32 m0, s65, 0x3000
    s_nop 0
    buffer_load_dwordx4 v4, s[48:51], s96 offen nt lds
    s_add_u32 s96, s77, 0x201400
    s_add_u32 m0, s65, 0x3400
    s_nop 0
    buffer_load_dwordx4 v4, s[48:51], s96 offen nt lds
    s_waitcnt vmcnt(14)
    v_mfma_f32_16x16x32_bf16 v[88:91], v[224:227], v[16:19], 0
    v_mfma_f32_16x16x32_bf16 v[24:27], v[232:235], v[16:19], 0
    v_mfma_f32_16x16x32_bf16 v[88:91], v[228:231], v[20:23], v[88:91]
    v_mfma_f32_16x16x32_bf16 v[24:27], v[236:239], v[20:23], v[24:27]
    v_permlane32_swap_b32 v84, v28
    v_permlane32_swap_b32 v85, v29
    v_permlane32_swap_b32 v86, v30
    v_permlane32_swap_b32 v87, v31
    v_add_f32_dpp v84, v28, v84 row_ror:8 row_mask:0xf bank_mask:0xf
    v_add_f32_dpp v85, v29, v85 row_ror:8 row_mask:0xf bank_mask:0xf
    v_add_f32_dpp v86, v30, v86 row_ror:8 row_mask:0xf bank_mask:0xf
    v_add_f32_dpp v87, v31, v87 row_ror:8 row_mask:0xf bank_mask:0xf
    v_cvt_pk_bf16_f32 v85, v84, v85
    v_lshlrev_b32 v84, 16, v85
    v_and_b32 v85, s15, v85
    v_mul_f32 v84, s64, v84
    v_mul_f32 v85, s64, v85
    v_cvt_pk_bf16_f32 v85, v84, v85
    v_lshlrev_b32 v84, 16, v85
    v_and_b32 v85, s15, v85
    v_cvt_pk_bf16_f32 v87, v86, v87
    v_lshlrev_b32 v86, 16, v87
    v_and_b32 v87, s15, v87
    v_mul_f32 v86, s64, v86
    v_mul_f32 v87, s64, v87
    v_cvt_pk_bf16_f32 v87, v86, v87
    v_lshlrev_b32 v86, 16, v87
    v_and_b32 v87, s15, v87
    v_mfma_f32_16x16x32_bf16 v[92:95], v[240:243], v[16:19], 0
    v_mfma_f32_16x16x32_bf16 v[28:31], v[248:251], v[16:19], 0
    v_mfma_f32_16x16x32_bf16 v[92:95], v[244:247], v[20:23], v[92:95]
    v_mfma_f32_16x16x32_bf16 v[28:31], v[252:255], v[20:23], v[28:31]
    v_permlane32_swap_b32 v88, v24
    v_permlane32_swap_b32 v89, v25
    v_permlane32_swap_b32 v90, v26
    v_permlane32_swap_b32 v91, v27
    v_add_f32_dpp v88, v24, v88 row_ror:8 row_mask:0xf bank_mask:0xf
    v_add_f32_dpp v89, v25, v89 row_ror:8 row_mask:0xf bank_mask:0xf
    v_add_f32_dpp v90, v26, v90 row_ror:8 row_mask:0xf bank_mask:0xf
    v_add_f32_dpp v91, v27, v91 row_ror:8 row_mask:0xf bank_mask:0xf
    v_cvt_pk_bf16_f32 v89, v88, v89
    v_lshlrev_b32 v88, 16, v89
    v_and_b32 v89, s15, v89
    v_mul_f32 v88, s64, v88
    v_mul_f32 v89, s64, v89
    v_cvt_pk_bf16_f32 v89, v88, v89
    v_lshlrev_b32 v88, 16, v89
    v_and_b32 v89, s15, v89
    v_cvt_pk_bf16_f32 v91, v90, v91
    v_lshlrev_b32 v90, 16, v91
    v_and_b32 v91, s15, v91
    v_mul_f32 v90, s64, v90
    v_mul_f32 v91, s64, v91
    v_cvt_pk_bf16_f32 v91, v90, v91
    v_lshlrev_b32 v90, 16, v91
    v_and_b32 v91, s15, v91
    s_add_u32 s96, s77, 0x201800
    s_add_u32 m0, s65, 0x3800
    s_nop 0
    buffer_load_dwordx4 v4, s[48:51], s96 offen nt lds
    s_add_u32 s96, s77, 0x201c00
    s_add_u32 m0, s65, 0x3c00
    s_nop 0
    buffer_load_dwordx4 v4, s[48:51], s96 offen nt lds
    v_permlane32_swap_b32 v92, v28
    v_permlane32_swap_b32 v93, v29
    v_permlane32_swap_b32 v94, v30
    v_permlane32_swap_b32 v95, v31
    v_add_f32_dpp v92, v28, v92 row_ror:8 row_mask:0xf bank_mask:0xf
    v_add_f32_dpp v93, v29, v93 row_ror:8 row_mask:0xf bank_mask:0xf
    v_add_f32_dpp v94, v30, v94 row_ror:8 row_mask:0xf bank_mask:0xf
    v_add_f32_dpp v95, v31, v95 row_ror:8 row_mask:0xf bank_mask:0xf
    v_cvt_pk_bf16_f32 v93, v92, v93
    v_lshlrev_b32 v92, 16, v93
    v_and_b32 v93, s15, v93
    v_mul_f32 v92, s64, v92
    v_mul_f32 v93, s64, v93
    v_cvt_pk_bf16_f32 v93, v92, v93
    v_lshlrev_b32 v92, 16, v93
    v_and_b32 v93, s15, v93
    v_cvt_pk_bf16_f32 v95, v94, v95
    v_lshlrev_b32 v94, 16, v95
    v_and_b32 v95, s15, v95
    v_mul_f32 v94, s64, v94
    v_mul_f32 v95, s64, v95
    v_cvt_pk_bf16_f32 v95, v94, v95
    v_lshlrev_b32 v94, 16, v95
    v_and_b32 v95, s15, v95
    v_mov_b32 v16, v5
    v_max_f32 v5, v32, v33
    v_max3_f32 v5, v5, v34, v35
    v_max3_f32 v5, v5, v36, v37
    v_max3_f32 v5, v5, v38, v39
    v_max3_f32 v5, v5, v40, v41
    v_max3_f32 v5, v5, v42, v43
    v_max3_f32 v5, v5, v44, v45
    v_max3_f32 v5, v5, v46, v47
    v_max3_f32 v5, v5, v48, v49
    v_max3_f32 v5, v5, v50, v51
    v_max3_f32 v5, v5, v52, v53
    v_max3_f32 v5, v5, v54, v55
    v_max3_f32 v5, v5, v56, v57
    v_max3_f32 v5, v5, v58, v59
    v_max3_f32 v5, v5, v60, v61
    v_max3_f32 v5, v5, v62, v63
    v_max3_f32 v5, v5, v64, v65
    v_max3_f32 v5, v5, v66, v67
    v_max3_f32 v5, v5, v68, v69
    v_max3_f32 v5, v5, v70, v71
    v_max3_f32 v5, v5, v72, v73
    v_max3_f32 v5, v5, v74, v75
    v_max3_f32 v5, v5, v76, v77
    v_max3_f32 v5, v5, v78, v79
    v_max3_f32 v5, v5, v80, v81
    v_max3_f32 v5, v5, v82, v83
    v_max3_f32 v5, v5, v84, v85
    v_max3_f32 v5, v5, v86, v87
    v_max3_f32 v5, v5, v88, v89
    v_max3_f32 v5, v5, v90, v91
    v_max3_f32 v5, v5, v92, v93
    v_max3_f32 v5, v5, v94, v95
    v_mov_b32 v10, v5
    s_nop 1
    v_permlane16_swap_b32 v10, v5
    v_max_f32 v5, v5, v10
    v_mov_b32 v10, v5
    s_nop 1
    v_permlane32_swap_b32 v10, v5
    v_max_f32 v5, v5, v10
    s_add_u32 s96, s77, 0x400000
    s_add_u32 m0, s65, 0x4000
    s_nop 0
    buffer_load_dwordx4 v4, s[48:51], s96 offen nt lds
    v_sub_f32 v32, v32, v5
    v_mul_f32 v32, s79, v32
    v_exp_f32 v32, v32
    v_sub_f32 v33, v33, v5
    v_mul_f32 v33, s79, v33
    v_exp_f32 v33, v33
    v_sub_f32 v34, v34, v5
    v_mul_f32 v34, s79, v34
    v_exp_f32 v34, v34
    v_sub_f32 v35, v35, v5
    v_mul_f32 v35, s79, v35
    v_exp_f32 v35, v35
    v_sub_f32 v36, v36, v5
    v_mul_f32 v36, s79, v36
    v_exp_f32 v36, v36
    v_sub_f32 v37, v37, v5
    v_mul_f32 v37, s79, v37
    v_exp_f32 v37, v37
    v_sub_f32 v38, v38, v5
    v_mul_f32 v38, s79, v38
    v_exp_f32 v38, v38
    v_sub_f32 v39, v39, v5
    v_mul_f32 v39, s79, v39
    v_exp_f32 v39, v39
    v_sub_f32 v40, v40, v5
    v_mul_f32 v40, s79, v40
    v_exp_f32 v40, v40
    v_sub_f32 v41, v41, v5
    v_mul_f32 v41, s79, v41
    v_exp_f32 v41, v41
    v_sub_f32 v42, v42, v5
    v_mul_f32 v42, s79, v42
    v_exp_f32 v42, v42
    v_sub_f32 v43, v43, v5
    v_mul_f32 v43, s79, v43
    v_exp_f32 v43, v43
    v_sub_f32 v44, v44, v5
    v_mul_f32 v44, s79, v44
    v_exp_f32 v44, v44
    v_sub_f32 v45, v45, v5
    v_mul_f32 v45, s79, v45
    v_exp_f32 v45, v45
    v_sub_f32 v46, v46, v5
    v_mul_f32 v46, s79, v46
    v_exp_f32 v46, v46
    v_sub_f32 v47, v47, v5
    v_mul_f32 v47, s79, v47
    v_exp_f32 v47, v47
    s_add_u32 s96, s77, 0x400400
    s_add_u32 m0, s65, 0x4400
    s_nop 0
    buffer_load_dwordx4 v4, s[48:51], s96 offen nt lds
    v_sub_f32 v48, v48, v5
    v_mul_f32 v48, s79, v48
    v_exp_f32 v48, v48
    v_sub_f32 v49, v49, v5
    v_mul_f32 v49, s79, v49
    v_exp_f32 v49, v49
    v_sub_f32 v50, v50, v5
    v_mul_f32 v50, s79, v50
    v_exp_f32 v50, v50
    v_sub_f32 v51, v51, v5
    v_mul_f32 v51, s79, v51
    v_exp_f32 v51, v51
    v_sub_f32 v52, v52, v5
    v_mul_f32 v52, s79, v52
    v_exp_f32 v52, v52
    v_sub_f32 v53, v53, v5
    v_mul_f32 v53, s79, v53
    v_exp_f32 v53, v53
    v_sub_f32 v54, v54, v5
    v_mul_f32 v54, s79, v54
    v_exp_f32 v54, v54
    v_sub_f32 v55, v55, v5
    v_mul_f32 v55, s79, v55
    v_exp_f32 v55, v55
    v_sub_f32 v56, v56, v5
    v_mul_f32 v56, s79, v56
    v_exp_f32 v56, v56
    v_sub_f32 v57, v57, v5
    v_mul_f32 v57, s79, v57
    v_exp_f32 v57, v57
    v_sub_f32 v58, v58, v5
    v_mul_f32 v58, s79, v58
    v_exp_f32 v58, v58
    v_sub_f32 v59, v59, v5
    v_mul_f32 v59, s79, v59
    v_exp_f32 v59, v59
    v_sub_f32 v60, v60, v5
    v_mul_f32 v60, s79, v60
    v_exp_f32 v60, v60
    v_sub_f32 v61, v61, v5
    v_mul_f32 v61, s79, v61
    v_exp_f32 v61, v61
    v_sub_f32 v62, v62, v5
    v_mul_f32 v62, s79, v62
    v_exp_f32 v62, v62
    v_sub_f32 v63, v63, v5
    v_mul_f32 v63, s79, v63
    v_exp_f32 v63, v63
    s_add_u32 s96, s77, 0x400800
    s_add_u32 m0, s65, 0x4800
    s_nop 0
    buffer_load_dwordx4 v4, s[48:51], s96 offen nt lds
    v_sub_f32 v64, v64, v5
    v_mul_f32 v64, s79, v64
    v_exp_f32 v64, v64
    v_sub_f32 v65, v65, v5
    v_mul_f32 v65, s79, v65
    v_exp_f32 v65, v65
    v_sub_f32 v66, v66, v5
    v_mul_f32 v66, s79, v66
    v_exp_f32 v66, v66
    v_sub_f32 v67, v67, v5
    v_mul_f32 v67, s79, v67
    v_exp_f32 v67, v67
    v_sub_f32 v68, v68, v5
    v_mul_f32 v68, s79, v68
    v_exp_f32 v68, v68
    v_sub_f32 v69, v69, v5
    v_mul_f32 v69, s79, v69
    v_exp_f32 v69, v69
    v_sub_f32 v70, v70, v5
    v_mul_f32 v70, s79, v70
    v_exp_f32 v70, v70
    v_sub_f32 v71, v71, v5
    v_mul_f32 v71, s79, v71
    v_exp_f32 v71, v71
    v_sub_f32 v72, v72, v5
    v_mul_f32 v72, s79, v72
    v_exp_f32 v72, v72
    v_sub_f32 v73, v73, v5
    v_mul_f32 v73, s79, v73
    v_exp_f32 v73, v73
    v_sub_f32 v74, v74, v5
    v_mul_f32 v74, s79, v74
    v_exp_f32 v74, v74
    v_sub_f32 v75, v75, v5
    v_mul_f32 v75, s79, v75
    v_exp_f32 v75, v75
    v_sub_f32 v76, v76, v5
    v_mul_f32 v76, s79, v76
    v_exp_f32 v76, v76
    v_sub_f32 v77, v77, v5
    v_mul_f32 v77, s79, v77
    v_exp_f32 v77, v77
    v_sub_f32 v78, v78, v5
    v_mul_f32 v78, s79, v78
    v_exp_f32 v78, v78
    v_sub_f32 v79, v79, v5
    v_mul_f32 v79, s79, v79
    v_exp_f32 v79, v79
    s_add_u32 s96, s77, 0x400c00
    s_add_u32 m0, s65, 0x4c00
    s_nop 0
    buffer_load_dwordx4 v4, s[48:51], s96 offen nt lds
    v_sub_f32 v80, v80, v5
    v_mul_f32 v80, s79, v80
    v_exp_f32 v80, v80
    v_sub_f32 v81, v81, v5
    v_mul_f32 v81, s79, v81
    v_exp_f32 v81, v81
    v_sub_f32 v82, v82, v5
    v_mul_f32 v82, s79, v82
    v_exp_f32 v82, v82
    v_sub_f32 v83, v83, v5
    v_mul_f32 v83, s79, v83
    v_exp_f32 v83, v83
    v_sub_f32 v84, v84, v5
    v_mul_f32 v84, s79, v84
    v_exp_f32 v84, v84
    v_sub_f32 v85, v85, v5
    v_mul_f32 v85, s79, v85
    v_exp_f32 v85, v85
    v_sub_f32 v86, v86, v5
    v_mul_f32 v86, s79, v86
    v_exp_f32 v86, v86
    v_sub_f32 v87, v87, v5
    v_mul_f32 v87, s79, v87
    v_exp_f32 v87, v87
    v_sub_f32 v88, v88, v5
    v_mul_f32 v88, s79, v88
    v_exp_f32 v88, v88
    v_sub_f32 v89, v89, v5
    v_mul_f32 v89, s79, v89
    v_exp_f32 v89, v89
    v_sub_f32 v90, v90, v5
    v_mul_f32 v90, s79, v90
    v_exp_f32 v90, v90
    v_sub_f32 v91, v91, v5
    v_mul_f32 v91, s79, v91
    v_exp_f32 v91, v91
    v_sub_f32 v92, v92, v5
    v_mul_f32 v92, s79, v92
    v_exp_f32 v92, v92
    v_sub_f32 v93, v93, v5
    v_mul_f32 v93, s79, v93
    v_exp_f32 v93, v93
    v_sub_f32 v94, v94, v5
    v_mul_f32 v94, s79, v94
    v_exp_f32 v94, v94
    v_sub_f32 v95, v95, v5
    v_mul_f32 v95, s79, v95
    v_exp_f32 v95, v95
    s_add_u32 s96, s77, 0x401000
    s_add_u32 m0, s65, 0x5000
    s_nop 0
    buffer_load_dwordx4 v4, s[48:51], s96 offen nt lds
    v_add_f32 v10, v32, v33
    v_add_f32 v11, v34, v35
    v_add_f32 v10, v10, v36
    v_add_f32 v11, v11, v37
    v_add_f32 v10, v10, v38
    v_add_f32 v11, v11, v39
    v_add_f32 v10, v10, v40
    v_add_f32 v11, v11, v41
    v_add_f32 v10, v10, v42
    v_add_f32 v11, v11, v43
    v_add_f32 v10, v10, v44
    v_add_f32 v11, v11, v45
    v_add_f32 v10, v10, v46
    v_add_f32 v11, v11, v47
    v_add_f32 v10, v10, v48
    v_add_f32 v11, v11, v49
    v_add_f32 v10, v10, v50
    v_add_f32 v11, v11, v51
    v_add_f32 v10, v10, v52
    v_add_f32 v11, v11, v53
    v_add_f32 v10, v10, v54
    v_add_f32 v11, v11, v55
    v_add_f32 v10, v10, v56
    v_add_f32 v11, v11, v57
    v_add_f32 v10, v10, v58
    v_add_f32 v11, v11, v59
    v_add_f32 v10, v10, v60
    v_add_f32 v11, v11, v61
    v_add_f32 v10, v10, v62
    v_add_f32 v11, v11, v63
    v_add_f32 v10, v10, v64
    v_add_f32 v11, v11, v65
    v_add_f32 v10, v10, v66
    v_add_f32 v11, v11, v67
    v_add_f32 v10, v10, v68
    v_add_f32 v11, v11, v69
    v_add_f32 v10, v10, v70
    v_add_f32 v11, v11, v71
    v_add_f32 v10, v10, v72
    v_add_f32 v11, v11, v73
    v_add_f32 v10, v10, v74
    v_add_f32 v11, v11, v75
    v_add_f32 v10, v10, v76
    v_add_f32 v11, v11, v77
    v_add_f32 v10, v10, v78
    v_add_f32 v11, v11, v79
    v_add_f32 v10, v10, v80
    v_add_f32 v11, v11, v81
    v_add_f32 v10, v10, v82
    v_add_f32 v11, v11, v83
    v_add_f32 v10, v10, v84
    v_add_f32 v11, v11, v85
    v_add_f32 v10, v10, v86
    v_add_f32 v11, v11, v87
    v_add_f32 v10, v10, v88
    v_add_f32 v11, v11, v89
    v_add_f32 v10, v10, v90
    v_add_f32 v11, v11, v91
    v_add_f32 v10, v10, v92
    v_add_f32 v11, v11, v93
    v_add_f32 v10, v10, v94
    v_add_f32 v11, v11, v95
    v_add_f32 v11, v10, v11
    v_mov_b32 v10, v5
    s_add_u32 s96, s77, 0x401400
    s_add_u32 m0, s65, 0x5400
    s_nop 0
    buffer_load_dwordx4 v4, s[48:51], s96 offen nt lds
    v_lshlrev_b32 v12, 3, v1
    v_lshl_add_u32 v12, v2, 6, v12
    s_lshl_b32 s96, s3, 8
    v_add_u32 v12, s96, v12
    s_mov_b32 exec_lo, 0x00ff00ff
    s_mov_b32 exec_hi, 0x00ff00ff
    ds_write_b64 v12, v[10:11] offset:3072
    s_mov_b64 exec, -1
    v_mov_b32 v9, 1
    s_mov_b64 exec, 1
    ds_add_u32 v7, v9 offset:8
    s_mov_b64 exec, -1
    v_cvt_pk_bf16_f32 v32, v32, v33
    v_cvt_pk_bf16_f32 v33, v34, v35
    v_cvt_pk_bf16_f32 v34, v36, v37
    v_cvt_pk_bf16_f32 v35, v38, v39
    v_cvt_pk_bf16_f32 v36, v40, v41
    v_cvt_pk_bf16_f32 v37, v42, v43
    v_cvt_pk_bf16_f32 v38, v44, v45
    v_cvt_pk_bf16_f32 v39, v46, v47
    v_cvt_pk_bf16_f32 v40, v48, v49
    v_cvt_pk_bf16_f32 v41, v50, v51
    v_cvt_pk_bf16_f32 v42, v52, v53
    v_cvt_pk_bf16_f32 v43, v54, v55
    v_cvt_pk_bf16_f32 v44, v56, v57
    v_cvt_pk_bf16_f32 v45, v58, v59
    v_cvt_pk_bf16_f32 v46, v60, v61
    v_cvt_pk_bf16_f32 v47, v62, v63
    v_cvt_pk_bf16_f32 v48, v64, v65
    v_cvt_pk_bf16_f32 v49, v66, v67
    v_cvt_pk_bf16_f32 v50, v68, v69
    v_cvt_pk_bf16_f32 v51, v70, v71
    v_cvt_pk_bf16_f32 v52, v72, v73
    v_cvt_pk_bf16_f32 v53, v74, v75
    v_cvt_pk_bf16_f32 v54, v76, v77
    v_cvt_pk_bf16_f32 v55, v78, v79
    v_cvt_pk_bf16_f32 v56, v80, v81
    v_cvt_pk_bf16_f32 v57, v82, v83
    v_cvt_pk_bf16_f32 v58, v84, v85
    v_cvt_pk_bf16_f32 v59, v86, v87
    v_cvt_pk_bf16_f32 v60, v88, v89
    v_cvt_pk_bf16_f32 v61, v90, v91
    v_cvt_pk_bf16_f32 v62, v92, v93
    v_cvt_pk_bf16_f32 v63, v94, v95
    s_add_u32 s96, s77, 0x401800
    s_add_u32 m0, s65, 0x5800
    s_waitcnt vmcnt(7)
    s_cmp_gt_u32 s36, 1
    s_cbranch_scc1 L_th_62
    s_waitcnt vmcnt(6)
    s_cmp_gt_u32 s36, 0
    s_cbranch_scc1 L_th_62
    s_waitcnt vmcnt(4)
L_th_62:
    buffer_load_dwordx4 v4, s[48:51], s96 offen nt lds
    ds_read_b128 v[224:227], v16 offset:0
    ds_read_b128 v[228:231], v16 offset:1024
    ds_read_b128 v[232:235], v16 offset:2048
    ds_read_b128 v[236:239], v16 offset:3072
    ds_read_b128 v[240:243], v16 offset:4096
    ds_read_b128 v[244:247], v16 offset:5120
    ds_read_b128 v[248:251], v16 offset:6144
    ds_read_b128 v[252:255], v16 offset:7168
    s_waitcnt lgkmcnt(0)
    v_perm_b32 v24, v228, v224, s12
    v_perm_b32 v25, v236, v232, s12
    v_perm_b32 v26, v244, v240, s12
    v_perm_b32 v27, v252, v248, s12
    v_perm_b32 v28, v228, v224, s13
    v_perm_b32 v29, v236, v232, s13
    v_perm_b32 v30, v244, v240, s13
    v_perm_b32 v31, v252, v248, s13
    v_mfma_f32_16x16x32_bf16 v[64:67], v[32:35], v[24:27], 0
    s_nop 0
    v_mfma_f32_16x16x32_bf16 v[68:71], v[32:35], v[28:31], 0
    s_add_u32 s96, s77, 0x401c00
    s_add_u32 m0, s65, 0x5c00
    s_waitcnt vmcnt(7)
    s_cmp_gt_u32 s36, 1
    s_nop 2
    s_cbranch_scc1 L_th_63
    s_waitcnt vmcnt(5)
    s_cmp_gt_u32 s36, 0
    s_cbranch_scc1 L_th_63
    s_waitcnt vmcnt(4)
L_th_63:
    buffer_load_dwordx4 v4, s[48:51], s96 offen nt lds
    v_perm_b32 v24, v229, v225, s12
    v_perm_b32 v25, v237, v233, s12
    v_perm_b32 v26, v245, v241, s12
    v_perm_b32 v27, v253, v249, s12
    v_perm_b32 v28, v229, v225, s13
    v_perm_b32 v29, v237, v233, s13
    v_perm_b32 v30, v245, v241, s13
    v_perm_b32 v31, v253, v249, s13
    v_mfma_f32_16x16x32_bf16 v[72:75], v[32:35], v[24:27], 0
    s_nop 0
    v_mfma_f32_16x16x32_bf16 v[76:79], v[32:35], v[28:31], 0
    v_perm_b32 v24, v230, v226, s12
    v_perm_b32 v25, v238, v234, s12
    v_perm_b32 v26, v246, v242, s12
    v_perm_b32 v27, v254, v250, s12
    v_perm_b32 v28, v230, v226, s13
    v_perm_b32 v29, v238, v234, s13
    v_perm_b32 v30, v246, v242, s13
    v_perm_b32 v31, v254, v250, s13
    v_mfma_f32_16x16x32_bf16 v[80:83], v[32:35], v[24:27], 0
    s_nop 0
    v_mfma_f32_16x16x32_bf16 v[84:87], v[32:35], v[28:31], 0
    s_add_u32 s96, s77, 0x600000
    s_waitcnt vmcnt(7)
    s_cmp_gt_u32 s36, 1
    s_nop 3
    s_cbranch_scc1 L_th_64
    s_waitcnt vmcnt(6)
    s_cmp_gt_u32 s36, 0
    s_cbranch_scc1 L_th_64
    s_waitcnt vmcnt(4)
L_th_64:
    buffer_load_dwordx4 v[96:99], v4, s[48:51], s96 offen offset:0 nt
    v_perm_b32 v24, v231, v227, s12
    v_perm_b32 v25, v239, v235, s12
    v_perm_b32 v26, v247, v243, s12
    v_perm_b32 v27, v255, v251, s12
    v_perm_b32 v28, v231, v227, s13
    v_perm_b32 v29, v239, v235, s13
    v_perm_b32 v30, v247, v243, s13
    v_perm_b32 v31, v255, v251, s13
    v_mfma_f32_16x16x32_bf16 v[88:91], v[32:35], v[24:27], 0
    s_nop 0
    v_mfma_f32_16x16x32_bf16 v[92:95], v[32:35], v[28:31], 0
    s_add_u32 s96, s77, 0x600000
    s_waitcnt vmcnt(7)
    s_cmp_gt_u32 s36, 1
    s_nop 3
    s_cbranch_scc1 L_th_65
    s_waitcnt vmcnt(5)
    s_cmp_gt_u32 s36, 0
    s_cbranch_scc1 L_th_65
    s_waitcnt vmcnt(4)
L_th_65:
    buffer_load_dwordx4 v[100:103], v4, s[48:51], s96 offen offset:1024 nt
    ds_read_b128 v[224:227], v16 offset:8192
    ds_read_b128 v[228:231], v16 offset:9216
    ds_read_b128 v[232:235], v16 offset:10240
    ds_read_b128 v[236:239], v16 offset:11264
    ds_read_b128 v[240:243], v16 offset:12288
    ds_read_b128 v[244:247], v16 offset:13312
    ds_read_b128 v[248:251], v16 offset:14336
    ds_read_b128 v[252:255], v16 offset:15360
    s_waitcnt lgkmcnt(0)
    v_perm_b32 v24, v228, v224, s12
    v_perm_b32 v25, v236, v232, s12
    v_perm_b32 v26, v244, v240, s12
    v_perm_b32 v27, v252, v248, s12
    v_perm_b32 v28, v228, v224, s13
    v_perm_b32 v29, v236, v232, s13
    v_perm_b32 v30, v244, v240, s13
    v_perm_b32 v31, v252, v248, s13
    v_mfma_f32_16x16x32_bf16 v[64:67], v[36:39], v[24:27], v[64:67]
    s_nop 0
    v_mfma_f32_16x16x32_bf16 v[68:71], v[36:39], v[28:31], v[68:71]
    s_add_u32 s96, s77, 0x600000
    s_waitcnt vmcnt(7)
    s_cmp_gt_u32 s36, 1
    s_nop 3
    s_cbranch_scc1 L_th_66
    s_waitcnt vmcnt(6)
    s_cmp_gt_u32 s36, 0
    s_cbranch_scc1 L_th_66
    s_waitcnt vmcnt(4)
L_th_66:
    buffer_load_dwordx4 v[104:107], v4, s[48:51], s96 offen offset:2048 nt
    v_perm_b32 v24, v229, v225, s12
    v_perm_b32 v25, v237, v233, s12
    v_perm_b32 v26, v245, v241, s12
    v_perm_b32 v27, v253, v249, s12
    v_perm_b32 v28, v229, v225, s13
    v_perm_b32 v29, v237, v233, s13
    v_perm_b32 v30, v245, v241, s13
    v_perm_b32 v31, v253, v249, s13
    v_mfma_f32_16x16x32_bf16 v[72:75], v[36:39], v[24:27], v[72:75]
    s_nop 0
    v_mfma_f32_16x16x32_bf16 v[76:79], v[36:39], v[28:31], v[76:79]
    v_perm_b32 v24, v230, v226, s12
    v_perm_b32 v25, v238, v234, s12
    v_perm_b32 v26, v246, v242, s12
    v_perm_b32 v27, v254, v250, s12
    v_perm_b32 v28, v230, v226, s13
    v_perm_b32 v29, v238, v234, s13
    v_perm_b32 v30, v246, v242, s13
    v_perm_b32 v31, v254, v250, s13
    v_mfma_f32_16x16x32_bf16 v[80:83], v[36:39], v[24:27], v[80:83]
    s_nop 0
    v_mfma_f32_16x16x32_bf16 v[84:87], v[36:39], v[28:31], v[84:87]
    s_add_u32 s96, s77, 0x600000
    s_waitcnt vmcnt(7)
    s_cmp_gt_u32 s36, 1
    s_nop 3
    s_cbranch_scc1 L_th_67
    s_waitcnt vmcnt(5)
    s_cmp_gt_u32 s36, 0
    s_cbranch_scc1 L_th_67
    s_waitcnt vmcnt(4)
L_th_67:
    buffer_load_dwordx4 v[108:111], v4, s[48:51], s96 offen offset:3072 nt
    v_perm_b32 v24, v231, v227, s12
    v_perm_b32 v25, v239, v235, s12
    v_perm_b32 v26, v247, v243, s12
    v_perm_b32 v27, v255, v251, s12
    v_perm_b32 v28, v231, v227, s13
    v_perm_b32 v29, v239, v235, s13
    v_perm_b32 v30, v247, v243, s13
    v_perm_b32 v31, v255, v251, s13
    v_mfma_f32_16x16x32_bf16 v[88:91], v[36:39], v[24:27], v[88:91]
    s_nop 0
    v_mfma_f32_16x16x32_bf16 v[92:95], v[36:39], v[28:31], v[92:95]
    s_add_u32 s96, s77, 0x601000
    s_waitcnt vmcnt(7)
    s_cmp_gt_u32 s36, 1
    s_nop 3
    s_cbranch_scc1 L_th_68
    s_waitcnt vmcnt(6)
    s_cmp_gt_u32 s36, 0
    s_cbranch_scc1 L_th_68
    s_waitcnt vmcnt(4)
L_th_68:
    buffer_load_dwordx4 v[112:115], v4, s[48:51], s96 offen offset:0 nt
    s_add_u32 s96, s77, 0x601000
    s_waitcnt vmcnt(7)
    s_cmp_gt_u32 s36, 1
    s_cbranch_scc1 L_th_69
    s_waitcnt vmcnt(5)
    s_cmp_gt_u32 s36, 0
    s_cbranch_scc1 L_th_69
    s_waitcnt vmcnt(4)
L_th_69:
    buffer_load_dwordx4 v[116:119], v4, s[48:51], s96 offen offset:1024 nt
    s_add_u32 s96, s77, 0x601000
    s_waitcnt vmcnt(7)
    s_cmp_gt_u32 s36, 1
    s_cbranch_scc1 L_th_70
    s_waitcnt vmcnt(6)
    s_cmp_gt_u32 s36, 0
    s_cbranch_scc1 L_th_70
    s_waitcnt vmcnt(4)
L_th_70:
    buffer_load_dwordx4 v[120:123], v4, s[48:51], s96 offen offset:2048 nt
    s_add_u32 s96, s77, 0x601000
    s_waitcnt vmcnt(7)
    s_cmp_gt_u32 s36, 1
    s_cbranch_scc1 L_th_71
    s_waitcnt vmcnt(5)
    s_cmp_gt_u32 s36, 0
    s_cbranch_scc1 L_th_71
    s_waitcnt vmcnt(4)
L_th_71:
    buffer_load_dwordx4 v[124:127], v4, s[48:51], s96 offen offset:3072 nt
    v_mov_b32 v9, 1
    s_mov_b64 exec, 1
    ds_add_u32 v7, v9 offset:36
    s_mov_b64 exec, -1
    ds_read_b128 v[224:227], v16 offset:16384
    ds_read_b128 v[228:231], v16 offset:17408
    ds_read_b128 v[232:235], v16 offset:18432
    ds_read_b128 v[236:239], v16 offset:19456
    ds_read_b128 v[240:243], v16 offset:20480
    ds_read_b128 v[244:247], v16 offset:21504
    ds_read_b128 v[248:251], v16 offset:22528
    ds_read_b128 v[252:255], v16 offset:23552
    s_waitcnt lgkmcnt(0)
    v_perm_b32 v24, v228, v224, s12
    v_perm_b32 v25, v236, v232, s12
    v_perm_b32 v26, v244, v240, s12
    v_perm_b32 v27, v252, v248, s12
    v_perm_b32 v28, v228, v224, s13
    v_perm_b32 v29, v236, v232, s13
    v_perm_b32 v30, v244, v240, s13
    v_perm_b32 v31, v252, v248, s13
    v_mfma_f32_16x16x32_bf16 v[64:67], v[40:43], v[24:27], v[64:67]
    s_nop 0
    v_mfma_f32_16x16x32_bf16 v[68:71], v[40:43], v[28:31], v[68:71]
    s_add_u32 s96, s77, 0x800000
    s_waitcnt vmcnt(7)
    s_cmp_gt_u32 s36, 1
    s_nop 3
    s_cbranch_scc1 L_th_72
    s_waitcnt vmcnt(6)
    s_cmp_gt_u32 s36, 0
    s_cbranch_scc1 L_th_72
    s_waitcnt vmcnt(4)
L_th_72:
    buffer_load_dwordx4 v[128:131], v4, s[48:51], s96 offen offset:0 nt
    v_perm_b32 v24, v229, v225, s12
    v_perm_b32 v25, v237, v233, s12
    v_perm_b32 v26, v245, v241, s12
    v_perm_b32 v27, v253, v249, s12
    v_perm_b32 v28, v229, v225, s13
    v_perm_b32 v29, v237, v233, s13
    v_perm_b32 v30, v245, v241, s13
    v_perm_b32 v31, v253, v249, s13
    v_mfma_f32_16x16x32_bf16 v[72:75], v[40:43], v[24:27], v[72:75]
    s_nop 0
    v_mfma_f32_16x16x32_bf16 v[76:79], v[40:43], v[28:31], v[76:79]
    v_perm_b32 v24, v230, v226, s12
    v_perm_b32 v25, v238, v234, s12
    v_perm_b32 v26, v246, v242, s12
    v_perm_b32 v27, v254, v250, s12
    v_perm_b32 v28, v230, v226, s13
    v_perm_b32 v29, v238, v234, s13
    v_perm_b32 v30, v246, v242, s13
    v_perm_b32 v31, v254, v250, s13
    v_mfma_f32_16x16x32_bf16 v[80:83], v[40:43], v[24:27], v[80:83]
    s_nop 0
    v_mfma_f32_16x16x32_bf16 v[84:87], v[40:43], v[28:31], v[84:87]
    s_add_u32 s96, s77, 0x800000
    s_waitcnt vmcnt(7)
    s_cmp_gt_u32 s36, 1
    s_nop 3
    s_cbranch_scc1 L_th_73
    s_waitcnt vmcnt(5)
    s_cmp_gt_u32 s36, 0
    s_cbranch_scc1 L_th_73
    s_waitcnt vmcnt(4)
L_th_73:
    buffer_load_dwordx4 v[132:135], v4, s[48:51], s96 offen offset:1024 nt
    v_perm_b32 v24, v231, v227, s12
    v_perm_b32 v25, v239, v235, s12
    v_perm_b32 v26, v247, v243, s12
    v_perm_b32 v27, v255, v251, s12
    v_perm_b32 v28, v231, v227, s13
    v_perm_b32 v29, v239, v235, s13
    v_perm_b32 v30, v247, v243, s13
    v_perm_b32 v31, v255, v251, s13
    v_mfma_f32_16x16x32_bf16 v[88:91], v[40:43], v[24:27], v[88:91]
    s_nop 0
    v_mfma_f32_16x16x32_bf16 v[92:95], v[40:43], v[28:31], v[92:95]
    s_add_u32 s96, s77, 0x800000
    s_waitcnt vmcnt(7)
    s_cmp_gt_u32 s36, 1
    s_nop 3
    s_cbranch_scc1 L_th_74
    s_waitcnt vmcnt(6)
    s_cmp_gt_u32 s36, 0
    s_cbranch_scc1 L_th_74
    s_waitcnt vmcnt(4)
L_th_74:
    buffer_load_dwordx4 v[136:139], v4, s[48:51], s96 offen offset:2048 nt
    s_add_u32 s96, s77, 0x800000
    s_waitcnt vmcnt(7)
    s_cmp_gt_u32 s36, 1
    s_cbranch_scc1 L_th_75
    s_waitcnt vmcnt(5)
    s_cmp_gt_u32 s36, 0
    s_cbranch_scc1 L_th_75
    s_waitcnt vmcnt(4)
L_th_75:
    buffer_load_dwordx4 v[140:143], v4, s[48:51], s96 offen offset:3072 nt
    s_add_u32 s96, s77, 0x801000
    s_waitcnt vmcnt(7)
    s_cmp_gt_u32 s36, 1
    s_cbranch_scc1 L_th_76
    s_waitcnt vmcnt(6)
    s_cmp_gt_u32 s36, 0
    s_cbranch_scc1 L_th_76
    s_waitcnt vmcnt(4)
L_th_76:
    buffer_load_dwordx4 v[144:147], v4, s[48:51], s96 offen offset:0 nt
    s_add_u32 s96, s77, 0x801000
    s_waitcnt vmcnt(7)
    s_cmp_gt_u32 s36, 1
    s_cbranch_scc1 L_th_77
    s_waitcnt vmcnt(5)
    s_cmp_gt_u32 s36, 0
    s_cbranch_scc1 L_th_77
    s_waitcnt vmcnt(4)
L_th_77:
    buffer_load_dwordx4 v[148:151], v4, s[48:51], s96 offen offset:1024 nt
    s_add_u32 s96, s77, 0x801000
    s_waitcnt vmcnt(7)
    s_cmp_gt_u32 s36, 1
    s_cbranch_scc1 L_th_78
    s_waitcnt vmcnt(6)
    s_cmp_gt_u32 s36, 0
    s_cbranch_scc1 L_th_78
    s_waitcnt vmcnt(4)
L_th_78:
    buffer_load_dwordx4 v[152:155], v4, s[48:51], s96 offen offset:2048 nt
    s_add_u32 s96, s77, 0x801000
    s_waitcnt vmcnt(7)
    s_cmp_gt_u32 s36, 1
    s_cbranch_scc1 L_th_79
    s_waitcnt vmcnt(5)
    s_cmp_gt_u32 s36, 0
    s_cbranch_scc1 L_th_79
    s_waitcnt vmcnt(4)
L_th_79:
    buffer_load_dwordx4 v[156:159], v4, s[48:51], s96 offen offset:3072 nt
    v_perm_b32 v24, v100, v96, s12
    v_perm_b32 v25, v108, v104, s12
    v_perm_b32 v26, v116, v112, s12
    v_perm_b32 v27, v124, v120, s12
    v_perm_b32 v28, v100, v96, s13
    v_perm_b32 v29, v108, v104, s13
    v_perm_b32 v30, v116, v112, s13
    v_perm_b32 v31, v124, v120, s13
    v_mfma_f32_16x16x32_bf16 v[64:67], v[44:47], v[24:27], v[64:67]
    s_nop 0
    v_mfma_f32_16x16x32_bf16 v[68:71], v[44:47], v[28:31], v[68:71]
    v_perm_b32 v24, v101, v97, s12
    v_perm_b32 v25, v109, v105, s12
    v_perm_b32 v26, v117, v113, s12
    v_perm_b32 v27, v125, v121, s12
    v_perm_b32 v28, v101, v97, s13
    v_perm_b32 v29, v109, v105, s13
    v_perm_b32 v30, v117, v113, s13
    v_perm_b32 v31, v125, v121, s13
    v_mfma_f32_16x16x32_bf16 v[72:75], v[44:47], v[24:27], v[72:75]
    s_nop 0
    v_mfma_f32_16x16x32_bf16 v[76:79], v[44:47], v[28:31], v[76:79]
    s_add_u32 s96, s77, 0xa00000
    s_waitcnt vmcnt(7)
    s_cmp_gt_u32 s36, 1
    s_nop 3
    s_cbranch_scc1 L_th_80
    s_waitcnt vmcnt(6)
    s_cmp_gt_u32 s36, 0
    s_cbranch_scc1 L_th_80
    s_waitcnt vmcnt(4)
L_th_80:
    buffer_load_dwordx4 v[160:163], v4, s[48:51], s96 offen offset:0 nt
    v_perm_b32 v24, v102, v98, s12
    v_perm_b32 v25, v110, v106, s12
    v_perm_b32 v26, v118, v114, s12
    v_perm_b32 v27, v126, v122, s12
    v_perm_b32 v28, v102, v98, s13
    v_perm_b32 v29, v110, v106, s13
    v_perm_b32 v30, v118, v114, s13
    v_perm_b32 v31, v126, v122, s13
    v_mfma_f32_16x16x32_bf16 v[80:83], v[44:47], v[24:27], v[80:83]
    s_nop 0
    v_mfma_f32_16x16x32_bf16 v[84:87], v[44:47], v[28:31], v[84:87]
    v_perm_b32 v24, v103, v99, s12
    v_perm_b32 v25, v111, v107, s12
    v_perm_b32 v26, v119, v115, s12
    v_perm_b32 v27, v127, v123, s12
    v_perm_b32 v28, v103, v99, s13
    v_perm_b32 v29, v111, v107, s13
    v_perm_b32 v30, v119, v115, s13
    v_perm_b32 v31, v127, v123, s13
    v_mfma_f32_16x16x32_bf16 v[88:91], v[44:47], v[24:27], v[88:91]
    s_nop 0
    v_mfma_f32_16x16x32_bf16 v[92:95], v[44:47], v[28:31], v[92:95]
    s_add_u32 s96, s77, 0xa00000
    s_waitcnt vmcnt(7)
    s_cmp_gt_u32 s36, 1
    s_nop 3
    s_cbranch_scc1 L_th_81
    s_waitcnt vmcnt(5)
    s_cmp_gt_u32 s36, 0
    s_cbranch_scc1 L_th_81
    s_waitcnt vmcnt(4)
L_th_81:
    buffer_load_dwordx4 v[164:167], v4, s[48:51], s96 offen offset:1024 nt
    s_add_u32 s96, s77, 0xa00000
    s_waitcnt vmcnt(7)
    s_cmp_gt_u32 s36, 1
    s_cbranch_scc1 L_th_82
    s_waitcnt vmcnt(6)
    s_cmp_gt_u32 s36, 0
    s_cbranch_scc1 L_th_82
    s_waitcnt vmcnt(4)
L_th_82:
    buffer_load_dwordx4 v[168:171], v4, s[48:51], s96 offen offset:2048 nt
    s_add_u32 s96, s77, 0xa00000
    s_waitcnt vmcnt(7)
    s_cmp_gt_u32 s36, 1
    s_cbranch_scc1 L_th_83
    s_waitcnt vmcnt(5)
    s_cmp_gt_u32 s36, 0
    s_cbranch_scc1 L_th_83
    s_waitcnt vmcnt(4)
L_th_83:
    buffer_load_dwordx4 v[172:175], v4, s[48:51], s96 offen offset:3072 nt
    s_add_u32 s96, s77, 0xa01000
    s_waitcnt vmcnt(7)
    s_cmp_gt_u32 s36, 1
    s_cbranch_scc1 L_th_84
    s_waitcnt vmcnt(6)
    s_cmp_gt_u32 s36, 0
    s_cbranch_scc1 L_th_84
    s_waitcnt vmcnt(4)
L_th_84:
    buffer_load_dwordx4 v[176:179], v4, s[48:51], s96 offen offset:0 nt
    s_add_u32 s96, s77, 0xa01000
    s_waitcnt vmcnt(7)
    s_cmp_gt_u32 s36, 1
    s_cbranch_scc1 L_th_85
    s_waitcnt vmcnt(5)
    s_cmp_gt_u32 s36, 0
    s_cbranch_scc1 L_th_85
    s_waitcnt vmcnt(4)
L_th_85:
    buffer_load_dwordx4 v[180:183], v4, s[48:51], s96 offen offset:1024 nt
    s_add_u32 s96, s77, 0xa01000
    s_waitcnt vmcnt(7)
    s_cmp_gt_u32 s36, 1
    s_cbranch_scc1 L_th_86
    s_waitcnt vmcnt(6)
    s_cmp_gt_u32 s36, 0
    s_cbranch_scc1 L_th_86
    s_waitcnt vmcnt(4)
L_th_86:
    buffer_load_dwordx4 v[184:187], v4, s[48:51], s96 offen offset:2048 nt
    s_add_u32 s96, s77, 0xa01000
    s_waitcnt vmcnt(7)
    s_cmp_gt_u32 s36, 1
    s_cbranch_scc1 L_th_87
    s_waitcnt vmcnt(5)
    s_cmp_gt_u32 s36, 0
    s_cbranch_scc1 L_th_87
    s_waitcnt vmcnt(4)
L_th_87:
    buffer_load_dwordx4 v[188:191], v4, s[48:51], s96 offen offset:3072 nt
    v_perm_b32 v24, v132, v128, s12
    v_perm_b32 v25, v140, v136, s12
    v_perm_b32 v26, v148, v144, s12
    v_perm_b32 v27, v156, v152, s12
    v_perm_b32 v28, v132, v128, s13
    v_perm_b32 v29, v140, v136, s13
    v_perm_b32 v30, v148, v144, s13
    v_perm_b32 v31, v156, v152, s13
    v_mfma_f32_16x16x32_bf16 v[64:67], v[48:51], v[24:27], v[64:67]
    s_nop 0
    v_mfma_f32_16x16x32_bf16 v[68:71], v[48:51], v[28:31], v[68:71]
    v_perm_b32 v24, v133, v129, s12
    v_perm_b32 v25, v141, v137, s12
    v_perm_b32 v26, v149, v145, s12
    v_perm_b32 v27, v157, v153, s12
    v_perm_b32 v28, v133, v129, s13
    v_perm_b32 v29, v141, v137, s13
    v_perm_b32 v30, v149, v145, s13
    v_perm_b32 v31, v157, v153, s13
    v_mfma_f32_16x16x32_bf16 v[72:75], v[48:51], v[24:27], v[72:75]
    s_nop 0
    v_mfma_f32_16x16x32_bf16 v[76:79], v[48:51], v[28:31], v[76:79]
    s_add_u32 s96, s77, 0xc00000
    s_waitcnt vmcnt(7)
    s_cmp_gt_u32 s36, 1
    s_nop 3
    s_cbranch_scc1 L_th_88
    s_waitcnt vmcnt(6)
    s_cmp_gt_u32 s36, 0
    s_cbranch_scc1 L_th_88
    s_waitcnt vmcnt(4)
L_th_88:
    buffer_load_dwordx4 v[192:195], v4, s[48:51], s96 offen offset:0 nt
    v_perm_b32 v24, v134, v130, s12
    v_perm_b32 v25, v142, v138, s12
    v_perm_b32 v26, v150, v146, s12
    v_perm_b32 v27, v158, v154, s12
    v_perm_b32 v28, v134, v130, s13
    v_perm_b32 v29, v142, v138, s13
    v_perm_b32 v30, v150, v146, s13
    v_perm_b32 v31, v158, v154, s13
    v_mfma_f32_16x16x32_bf16 v[80:83], v[48:51], v[24:27], v[80:83]
    s_nop 0
    v_mfma_f32_16x16x32_bf16 v[84:87], v[48:51], v[28:31], v[84:87]
    v_perm_b32 v24, v135, v131, s12
    v_perm_b32 v25, v143, v139, s12
    v_perm_b32 v26, v151, v147, s12
    v_perm_b32 v27, v159, v155, s12
    v_perm_b32 v28, v135, v131, s13
    v_perm_b32 v29, v143, v139, s13
    v_perm_b32 v30, v151, v147, s13
    v_perm_b32 v31, v159, v155, s13
    v_mfma_f32_16x16x32_bf16 v[88:91], v[48:51], v[24:27], v[88:91]
    s_nop 0
    v_mfma_f32_16x16x32_bf16 v[92:95], v[48:51], v[28:31], v[92:95]
    s_add_u32 s96, s77, 0xc00000
    s_waitcnt vmcnt(7)
    s_cmp_gt_u32 s36, 1
    s_nop 3
    s_cbranch_scc1 L_th_89
    s_waitcnt vmcnt(5)
    s_cmp_gt_u32 s36, 0
    s_cbranch_scc1 L_th_89
    s_waitcnt vmcnt(4)
L_th_89:
    buffer_load_dwordx4 v[196:199], v4, s[48:51], s96 offen offset:1024 nt
    s_add_u32 s96, s77, 0xc00000
    s_waitcnt vmcnt(7)
    s_cmp_gt_u32 s36, 1
    s_cbranch_scc1 L_th_90
    s_waitcnt vmcnt(6)
    s_cmp_gt_u32 s36, 0
    s_cbranch_scc1 L_th_90
    s_waitcnt vmcnt(4)
L_th_90:
    buffer_load_dwordx4 v[200:203], v4, s[48:51], s96 offen offset:2048 nt
    s_add_u32 s96, s77, 0xc00000
    s_waitcnt vmcnt(7)
    s_cmp_gt_u32 s36, 1
    s_cbranch_scc1 L_th_91
    s_waitcnt vmcnt(5)
    s_cmp_gt_u32 s36, 0
    s_cbranch_scc1 L_th_91
    s_waitcnt vmcnt(4)
L_th_91:
    buffer_load_dwordx4 v[204:207], v4, s[48:51], s96 offen offset:3072 nt
    s_add_u32 s96, s77, 0xc01000
    s_waitcnt vmcnt(7)
    s_cmp_gt_u32 s36, 1
    s_cbranch_scc1 L_th_92
    s_waitcnt vmcnt(6)
    s_cmp_gt_u32 s36, 0
    s_cbranch_scc1 L_th_92
    s_waitcnt vmcnt(4)
L_th_92:
    buffer_load_dwordx4 v[208:211], v4, s[48:51], s96 offen offset:0 nt
    s_add_u32 s96, s77, 0xc01000
    s_waitcnt vmcnt(7)
    s_cmp_gt_u32 s36, 1
    s_cbranch_scc1 L_th_93
    s_waitcnt vmcnt(5)
    s_cmp_gt_u32 s36, 0
    s_cbranch_scc1 L_th_93
    s_waitcnt vmcnt(4)
L_th_93:
    buffer_load_dwordx4 v[212:215], v4, s[48:51], s96 offen offset:1024 nt
    s_add_u32 s96, s77, 0xc01000
    s_waitcnt vmcnt(7)
    s_cmp_gt_u32 s36, 1
    s_cbranch_scc1 L_th_94
    s_waitcnt vmcnt(6)
    s_cmp_gt_u32 s36, 0
    s_cbranch_scc1 L_th_94
    s_waitcnt vmcnt(4)
L_th_94:
    buffer_load_dwordx4 v[216:219], v4, s[48:51], s96 offen offset:2048 nt
    s_add_u32 s96, s77, 0xc01000
    s_waitcnt vmcnt(7)
    s_cmp_gt_u32 s36, 1
    s_cbranch_scc1 L_th_95
    s_waitcnt vmcnt(5)
    s_cmp_gt_u32 s36, 0
    s_cbranch_scc1 L_th_95
    s_waitcnt vmcnt(4)
L_th_95:
    buffer_load_dwordx4 v[220:223], v4, s[48:51], s96 offen offset:3072 nt
    v_perm_b32 v24, v164, v160, s12
    v_perm_b32 v25, v172, v168, s12
    v_perm_b32 v26, v180, v176, s12
    v_perm_b32 v27, v188, v184, s12
    v_perm_b32 v28, v164, v160, s13
    v_perm_b32 v29, v172, v168, s13
    v_perm_b32 v30, v180, v176, s13
    v_perm_b32 v31, v188, v184, s13
    v_mfma_f32_16x16x32_bf16 v[64:67], v[52:55], v[24:27], v[64:67]
    s_nop 0
    v_mfma_f32_16x16x32_bf16 v[68:71], v[52:55], v[28:31], v[68:71]
    v_perm_b32 v24, v165, v161, s12
    v_perm_b32 v25, v173, v169, s12
    v_perm_b32 v26, v181, v177, s12
    v_perm_b32 v27, v189, v185, s12
    v_perm_b32 v28, v165, v161, s13
    v_perm_b32 v29, v173, v169, s13
    v_perm_b32 v30, v181, v177, s13
    v_perm_b32 v31, v189, v185, s13
    v_mfma_f32_16x16x32_bf16 v[72:75], v[52:55], v[24:27], v[72:75]
    s_nop 0
    v_mfma_f32_16x16x32_bf16 v[76:79], v[52:55], v[28:31], v[76:79]
    s_add_u32 s96, s77, 0xe00000
    s_waitcnt vmcnt(7)
    s_cmp_gt_u32 s36, 1
    s_nop 3
    s_cbranch_scc1 L_th_96
    s_waitcnt vmcnt(6)
    s_cmp_gt_u32 s36, 0
    s_cbranch_scc1 L_th_96
    s_waitcnt vmcnt(4)
L_th_96:
    buffer_load_dwordx4 v[224:227], v4, s[48:51], s96 offen offset:0 nt
    v_perm_b32 v24, v166, v162, s12
    v_perm_b32 v25, v174, v170, s12
    v_perm_b32 v26, v182, v178, s12
    v_perm_b32 v27, v190, v186, s12
    v_perm_b32 v28, v166, v162, s13
    v_perm_b32 v29, v174, v170, s13
    v_perm_b32 v30, v182, v178, s13
    v_perm_b32 v31, v190, v186, s13
    v_mfma_f32_16x16x32_bf16 v[80:83], v[52:55], v[24:27], v[80:83]
    s_nop 0
    v_mfma_f32_16x16x32_bf16 v[84:87], v[52:55], v[28:31], v[84:87]
    v_perm_b32 v24, v167, v163, s12
    v_perm_b32 v25, v175, v171, s12
    v_perm_b32 v26, v183, v179, s12
    v_perm_b32 v27, v191, v187, s12
    v_perm_b32 v28, v167, v163, s13
    v_perm_b32 v29, v175, v171, s13
    v_perm_b32 v30, v183, v179, s13
    v_perm_b32 v31, v191, v187, s13
    v_mfma_f32_16x16x32_bf16 v[88:91], v[52:55], v[24:27], v[88:91]
    s_nop 0
    v_mfma_f32_16x16x32_bf16 v[92:95], v[52:55], v[28:31], v[92:95]
    s_add_u32 s96, s77, 0xe00000
    s_waitcnt vmcnt(7)
    s_cmp_gt_u32 s36, 1
    s_nop 3
    s_cbranch_scc1 L_th_97
    s_waitcnt vmcnt(5)
    s_cmp_gt_u32 s36, 0
    s_cbranch_scc1 L_th_97
    s_waitcnt vmcnt(4)
L_th_97:
    buffer_load_dwordx4 v[228:231], v4, s[48:51], s96 offen offset:1024 nt
    s_add_u32 s96, s77, 0xe00000
    s_waitcnt vmcnt(7)
    s_cmp_gt_u32 s36, 1
    s_cbranch_scc1 L_th_98
    s_waitcnt vmcnt(6)
    s_cmp_gt_u32 s36, 0
    s_cbranch_scc1 L_th_98
    s_waitcnt vmcnt(4)
L_th_98:
    buffer_load_dwordx4 v[232:235], v4, s[48:51], s96 offen offset:2048 nt
    s_add_u32 s96, s77, 0xe00000
    s_waitcnt vmcnt(7)
    s_cmp_gt_u32 s36, 1
    s_cbranch_scc1 L_th_99
    s_waitcnt vmcnt(5)
    s_cmp_gt_u32 s36, 0
    s_cbranch_scc1 L_th_99
    s_waitcnt vmcnt(4)
L_th_99:
    buffer_load_dwordx4 v[236:239], v4, s[48:51], s96 offen offset:3072 nt
    s_add_u32 s96, s77, 0xe01000
    s_waitcnt vmcnt(7)
    s_cmp_gt_u32 s36, 1
    s_cbranch_scc1 L_th_100
    s_waitcnt vmcnt(6)
    s_cmp_gt_u32 s36, 0
    s_cbranch_scc1 L_th_100
    s_waitcnt vmcnt(4)
L_th_100:
    buffer_load_dwordx4 v[240:243], v4, s[48:51], s96 offen offset:0 nt
    s_add_u32 s96, s77, 0xe01000
    s_waitcnt vmcnt(7)
    s_cmp_gt_u32 s36, 1
    s_cbranch_scc1 L_th_101
    s_waitcnt vmcnt(5)
    s_cmp_gt_u32 s36, 0
    s_cbranch_scc1 L_th_101
    s_waitcnt vmcnt(4)
L_th_101:
    buffer_load_dwordx4 v[244:247], v4, s[48:51], s96 offen offset:1024 nt
    s_add_u32 s96, s77, 0xe01000
    s_waitcnt vmcnt(7)
    s_cmp_gt_u32 s36, 1
    s_cbranch_scc1 L_th_102
    s_waitcnt vmcnt(6)
    s_cmp_gt_u32 s36, 0
    s_cbranch_scc1 L_th_102
    s_waitcnt vmcnt(4)
L_th_102:
    buffer_load_dwordx4 v[248:251], v4, s[48:51], s96 offen offset:2048 nt
    s_add_u32 s96, s77, 0xe01000
    s_waitcnt vmcnt(7)
    s_cmp_gt_u32 s36, 1
    s_cbranch_scc1 L_th_103
    s_waitcnt vmcnt(5)
    s_cmp_gt_u32 s36, 0
    s_cbranch_scc1 L_th_103
    s_waitcnt vmcnt(4)
L_th_103:
    buffer_load_dwordx4 v[252:255], v4, s[48:51], s96 offen offset:3072 nt
    v_mov_b32 v9, 1
    s_mov_b64 exec, 1
    ds_add_u32 v7, v9 offset:16
    s_mov_b64 exec, -1
    v_perm_b32 v24, v196, v192, s12
    v_perm_b32 v25, v204, v200, s12
    v_perm_b32 v26, v212, v208, s12
    v_perm_b32 v27, v220, v216, s12
    v_perm_b32 v28, v196, v192, s13
    v_perm_b32 v29, v204, v200, s13
    v_perm_b32 v30, v212, v208, s13
    v_perm_b32 v31, v220, v216, s13
    v_mfma_f32_16x16x32_bf16 v[64:67], v[56:59], v[24:27], v[64:67]
    s_nop 0
    v_mfma_f32_16x16x32_bf16 v[68:71], v[56:59], v[28:31], v[68:71]
    v_perm_b32 v24, v197, v193, s12
    v_perm_b32 v25, v205, v201, s12
    v_perm_b32 v26, v213, v209, s12
    v_perm_b32 v27, v221, v217, s12
    v_perm_b32 v28, v197, v193, s13
    v_perm_b32 v29, v205, v201, s13
    v_perm_b32 v30, v213, v209, s13
    v_perm_b32 v31, v221, v217, s13
    v_mfma_f32_16x16x32_bf16 v[72:75], v[56:59], v[24:27], v[72:75]
    s_nop 0
    v_mfma_f32_16x16x32_bf16 v[76:79], v[56:59], v[28:31], v[76:79]
    v_perm_b32 v24, v198, v194, s12
    v_perm_b32 v25, v206, v202, s12
    v_perm_b32 v26, v214, v210, s12
    v_perm_b32 v27, v222, v218, s12
    v_perm_b32 v28, v198, v194, s13
    v_perm_b32 v29, v206, v202, s13
    v_perm_b32 v30, v214, v210, s13
    v_perm_b32 v31, v222, v218, s13
    v_mfma_f32_16x16x32_bf16 v[80:83], v[56:59], v[24:27], v[80:83]
    s_nop 0
    v_mfma_f32_16x16x32_bf16 v[84:87], v[56:59], v[28:31], v[84:87]
    v_perm_b32 v24, v199, v195, s12
    v_perm_b32 v25, v207, v203, s12
    v_perm_b32 v26, v215, v211, s12
    v_perm_b32 v27, v223, v219, s12
    v_perm_b32 v28, v199, v195, s13
    v_perm_b32 v29, v207, v203, s13
    v_perm_b32 v30, v215, v211, s13
    v_perm_b32 v31, v223, v219, s13
    v_mfma_f32_16x16x32_bf16 v[88:91], v[56:59], v[24:27], v[88:91]
    s_nop 0
    v_mfma_f32_16x16x32_bf16 v[92:95], v[56:59], v[28:31], v[92:95]
    s_nop 7
L_ldsw_104:
    ds_read_b32 v8, v7 offset:12
    s_waitcnt lgkmcnt(0)
    v_readfirstlane_b32 s96, v8
    s_nop 0
    s_cmp_ge_u32 s96, 1
    s_nop 1
    s_cbranch_scc1 L_ldsd_105
    s_sleep 2
    s_sub_u32 s76, s76, 1
    s_cmp_lg_u32 s76, 0
    s_cbranch_scc1 L_ldsw_104
    s_branch L_end
L_ldsd_105:
    v_and_b32 v8, 1, v0
    v_lshlrev_b32 v8, 4, v8
    ds_read_b128 v[96:99], v8 offset:5248
    ds_read_b128 v[100:103], v8 offset:5280
    ds_read_b128 v[104:107], v8 offset:5312
    ds_read_b128 v[108:111], v8 offset:5344
    v_mul_u32_u24 v17, 272, v1
    v_lshl_add_u32 v17, v2, 4, v17
    s_mul_i32 s96, s3, 4352
    v_add_u32 v17, s96, v17
    s_lshl_b32 s96, s3, 2
    v_add_u32 v18, s96, v2
    v_mul_u32_u24 v18, 272, v18
    v_lshl_add_u32 v18, v1, 4, v18
    s_lshl_b32 s99, s6, 12
    s_lshl_b32 s97, s3, 10
    s_add_u32 s99, s99, s97
    s_add_u32 s99, s99, 1048576
    v_mov_b32 v9, 1
    s_waitcnt vmcnt(0)
    v_perm_b32 v24, v228, v224, s12
    v_perm_b32 v25, v236, v232, s12
    v_perm_b32 v26, v244, v240, s12
    v_perm_b32 v27, v252, v248, s12
    v_perm_b32 v28, v228, v224, s13
    v_perm_b32 v29, v236, v232, s13
    v_perm_b32 v30, v244, v240, s13
    v_perm_b32 v31, v252, v248, s13
    v_mfma_f32_16x16x32_bf16 v[64:67], v[60:63], v[24:27], v[64:67]
    s_nop 0
    v_mfma_f32_16x16x32_bf16 v[68:71], v[60:63], v[28:31], v[68:71]
    v_perm_b32 v24, v229, v225, s12
    v_perm_b32 v25, v237, v233, s12
    v_perm_b32 v26, v245, v241, s12
    v_perm_b32 v27, v253, v249, s12
    v_perm_b32 v28, v229, v225, s13
    v_perm_b32 v29, v237, v233, s13
    v_perm_b32 v30, v245, v241, s13
    v_perm_b32 v31, v253, v249, s13
    v_mfma_f32_16x16x32_bf16 v[72:75], v[60:63], v[24:27], v[72:75]
    s_nop 0
    v_mfma_f32_16x16x32_bf16 v[76:79], v[60:63], v[28:31], v[76:79]
    s_mov_b64 exec, 0xffffffff
    ds_write_b128 v17, v[64:67] offset:12288
    ds_write_b128 v17, v[68:71] offset:12320
    s_mov_b64 exec, -1
    v_perm_b32 v24, v230, v226, s12
    v_perm_b32 v25, v238, v234, s12
    v_perm_b32 v26, v246, v242, s12
    v_perm_b32 v27, v254, v250, s12
    v_perm_b32 v28, v230, v226, s13
    v_perm_b32 v29, v238, v234, s13
    v_perm_b32 v30, v246, v242, s13
    v_perm_b32 v31, v254, v250, s13
    v_mfma_f32_16x16x32_bf16 v[80:83], v[60:63], v[24:27], v[80:83]
    s_nop 0
    v_mfma_f32_16x16x32_bf16 v[84:87], v[60:63], v[28:31], v[84:87]
    s_mov_b64 exec, 0xffffffff
    ds_write_b128 v17, v[72:75] offset:12352
    ds_write_b128 v17, v[76:79] offset:12384
    s_mov_b64 exec, -1
    v_perm_b32 v24, v231, v227, s12
    v_perm_b32 v25, v239, v235, s12
    v_perm_b32 v26, v247, v243, s12
    v_perm_b32 v27, v255, v251, s12
    v_perm_b32 v28, v231, v227, s13
    v_perm_b32 v29, v239, v235, s13
    v_perm_b32 v30, v247, v243, s13
    v_perm_b32 v31, v255, v251, s13
    v_mfma_f32_16x16x32_bf16 v[88:91], v[60:63], v[24:27], v[88:91]
    s_nop 0
    v_mfma_f32_16x16x32_bf16 v[92:95], v[60:63], v[28:31], v[92:95]
    s_mov_b64 exec, 0xffffffff
    ds_write_b128 v17, v[80:83] offset:12416
    ds_write_b128 v17, v[84:87] offset:12448
    s_mov_b64 exec, -1
    s_mov_b64 exec, 0xffffffff
    s_nop 0
    ds_write_b128 v17, v[88:91] offset:12480
    s_nop 0
    ds_write_b128 v17, v[92:95] offset:12512
    s_mov_b64 exec, -1
    s_mov_b64 exec, 1
    ds_add_u32 v7, v9 offset:20
    s_mov_b64 exec, -1
L_owait:
    ds_read_b32 v8, v7 offset:20
    ds_read_b128 v[128:131], v18 offset:12288
    ds_read_b128 v[132:135], v18 offset:16640
    ds_read_b128 v[136:139], v18 offset:20992
    ds_read_b128 v[140:143], v18 offset:25344
    s_waitcnt lgkmcnt(0)
    v_readfirstlane_b32 s96, v8
    s_nop 0
    s_cmp_eq_u32 s96, 4
    s_nop 1
    s_cbranch_scc1 L_oready
    s_sub_u32 s76, s76, 1
    s_cmp_lg_u32 s76, 0
    s_cbranch_scc1 L_owait
    s_branch L_end
L_oready:
    v_mul_f32 v128, v128, v96
    v_mul_f32 v129, v129, v97
    v_mul_f32 v130, v130, v98
    v_mul_f32 v131, v131, v99
    v_fmac_f32 v128, v132, v100
    v_fmac_f32 v129, v133, v101
    v_fmac_f32 v130, v134, v102
    v_fmac_f32 v131, v135, v103
    v_fmac_f32 v128, v136, v104
    v_fmac_f32 v129, v137, v105
    v_fmac_f32 v130, v138, v106
    v_fmac_f32 v131, v139, v107
    v_fmac_f32 v128, v140, v108
    v_fmac_f32 v129, v141, v109
    v_fmac_f32 v130, v142, v110
    v_fmac_f32 v131, v143, v111
    v_add_u32 v128, 0x200, v128
    v_and_or_b32 v128, v128, s14, v6
    v_add_u32 v129, 0x200, v129
    v_and_or_b32 v129, v129, s14, v6
    v_add_u32 v130, 0x200, v130
    v_and_or_b32 v130, v130, s14, v6
    v_add_u32 v131, 0x200, v131
    v_and_or_b32 v131, v131, s14, v6
    buffer_store_dwordx4 v[128:131], v4, s[72:75], s99 offen sc1
    v_mov_b32 v9, 1
    s_mov_b64 exec, 1
    ds_add_u32 v7, v9 offset:28
    s_mov_b64 exec, -1
    s_branch L_end
L_helper:
    s_mov_b32 s40, s16
    s_and_b32 s41, s17, 0xffff
    s_mov_b32 s42, 0x800
    s_mov_b32 s43, 0x20000
    s_mov_b32 s68, s34
    s_and_b32 s69, s35, 0xffff
    s_mov_b32 s70, 0x800
    s_mov_b32 s71, 0x20000
    s_cmp_ge_u32 s5, 16
    s_cbranch_scc1 L_roleM
    s_mov_b32 s56, s24
    s_and_b32 s57, s25, 0xffff
    s_mov_b32 s58, 0x800000
    s_mov_b32 s59, 0x20000
    s_mov_b32 s60, s32
    s_and_b32 s61, s33, 0xffff
    s_mov_b32 s62, 0x700000
    s_mov_b32 s63, 0x20000
    v_and_b32 v15, 31, v0
    v_lshlrev_b32 v60, 2, v15
    v_lshlrev_b32 v15, 5, v15
    v_lshrrev_b32 v8, 5, v0
    v_lshl_add_u32 v15, v8, 4, v15
    v_lshrrev_b32 v3, 3, v0
    v_lshlrev_b32 v3, 12, v3
    v_and_b32 v9, 7, v0
    v_lshl_add_u32 v3, v9, 4, v3
    v_lshlrev_b32 v57, 4, v9
    v_lshl_add_u32 v57, v2, 2, v57
    s_lshl_b32 s96, s67, 7
    v_add_u32 v57, s96, v57
    v_lshrrev_b32 v6, 5, v0
    v_lshlrev_b32 v6, 20, v6
    v_lshl_add_u32 v6, v60, 2, v6
    s_lshl_b32 s77, s8, 21
    s_and_b32 s98, s7, 31
    s_lshl_b32 s98, s98, 13
    s_add_u32 s77, s77, s98
    s_lshl_b32 s98, s67, 9
    s_add_u32 s77, s77, s98
    s_add_u32 s96, s77, 0
    buffer_load_dwordx4 v[192:195], v6, s[56:59], s96 offen offset:0
    s_add_u32 s96, s77, 0
    buffer_load_dwordx4 v[196:199], v6, s[56:59], s96 offen offset:2048
    s_add_u32 s96, s77, 4096
    buffer_load_dwordx4 v[200:203], v6, s[56:59], s96 offen offset:0
    s_add_u32 s96, s77, 4096
    buffer_load_dwordx4 v[204:207], v6, s[56:59], s96 offen offset:2048
    s_barrier
    s_add_u32 s96, s77, 262144
    buffer_load_dwordx4 v[208:211], v6, s[56:59], s96 offen offset:0
    s_add_u32 s96, s77, 262144
    buffer_load_dwordx4 v[212:215], v6, s[56:59], s96 offen offset:2048
    s_add_u32 s96, s77, 266240
    buffer_load_dwordx4 v[216:219], v6, s[56:59], s96 offen offset:0
    s_add_u32 s96, s77, 266240
    buffer_load_dwordx4 v[220:223], v6, s[56:59], s96 offen offset:2048
    s_add_u32 s96, s77, 524288
    buffer_load_dwordx4 v[224:227], v6, s[56:59], s96 offen offset:0
    s_add_u32 s96, s77, 524288
    buffer_load_dwordx4 v[228:231], v6, s[56:59], s96 offen offset:2048
    s_add_u32 s96, s77, 528384
    buffer_load_dwordx4 v[232:235], v6, s[56:59], s96 offen offset:0
    s_add_u32 s96, s77, 528384
    buffer_load_dwordx4 v[236:239], v6, s[56:59], s96 offen offset:2048
    s_add_u32 s96, s77, 786432
    buffer_load_dwordx4 v[240:243], v6, s[56:59], s96 offen offset:0
    s_add_u32 s96, s77, 786432
    buffer_load_dwordx4 v[244:247], v6, s[56:59], s96 offen offset:2048
    s_add_u32 s96, s77, 790528
    buffer_load_dwordx4 v[248:251], v6, s[56:59], s96 offen offset:0
    s_add_u32 s96, s77, 790528
    buffer_load_dwordx4 v[252:255], v6, s[56:59], s96 offen offset:2048
    s_waitcnt lgkmcnt(0)
    s_add_u32 s78, s78, 1
    s_and_b32 s10, s78, 0xffff
    s_and_b32 s11, s78, 0x3ff
    v_mov_b32 v5, s11
    s_lshl_b32 s66, s4, 4
    s_add_u32 s66, s66, s5
    s_lshl_b32 s66, s66, 12
    s_lshl_b32 s97, s67, 10
    s_add_u32 s66, s66, s97
    s_add_u32 s66, s66, 2097152
    s_lshl_b32 s97, s8, 18
    s_lshl_b32 s98, s67, 16
    s_add_u32 s97, s97, s98
    s_and_b32 s98, s7, 31
    s_lshl_b32 s98, s98, 7
    s_add_u32 s97, s97, s98
    v_add_u32 v56, s97, v3
    v_and_b32 v58, 3, v1
    v_lshlrev_b32 v58, 3, v58
    v_lshrrev_b32 v8, 5, v0
    v_lshl_add_u32 v58, v8, 2, v58
    v_lshrrev_b32 v9, 2, v1
    v_add_u32 v58, v58, v9
    v_lshlrev_b32 v58, 2, v58
    v_add_u32 v58, 8192, v58
    v_lshl_add_u32 v62, v8, 4, v1
    v_lshlrev_b32 v62, 2, v62
    v_add_u32 v62, 9216, v62
    s_mul_i32 s16, s4, 14
    s_add_u32 s16, s16, s5
    v_lshrrev_b32 v61, 3, v0
    v_mul_u32_u24 v61, 3584, v61
    v_and_b32 v9, 7, v0
    v_lshl_add_u32 v61, v9, 4, v61
    s_and_b32 s96, s67, 1
    s_mul_i32 s96, s96, 28672
    s_lshr_b32 s97, s67, 1
    s_mul_i32 s97, s97, 1792
    s_add_u32 s96, s96, s97
    s_mul_i32 s97, s4, 57344
    s_add_u32 s96, s96, s97
    s_lshl_b32 s97, s5, 7
    s_add_u32 s96, s96, s97
    v_add_u32 v61, s96, v61
    v_lshlrev_b32 v43, 12, v2
    v_lshl_add_u32 v43, v1, 4, v43
    s_lshl_b32 s96, s4, 16
    s_lshl_b32 s97, s67, 14
    s_add_u32 s96, s96, s97
    s_lshl_b32 s97, s5, 8
    s_add_u32 s96, s96, s97
    v_add_u32 v43, s96, v43
    v_lshlrev_b32 v63, 4, v1
    v_lshl_add_u32 v63, v2, 2, v63
    s_lshl_b32 s96, s67, 8
    v_add_u32 v63, s96, v63
    v_lshrrev_b32 v8, 5, v0
    v_lshlrev_b32 v45, 15, v8
    v_lshl_add_u32 v45, v1, 4, v45
    s_lshl_b32 s20, s67, 16
    s_lshl_b32 s97, s5, 11
    s_add_u32 s20, s20, s97
    s_lshl_b32 s97, s4, 8
    s_add_u32 s20, s20, s97
    s_add_u32 s20, s20, 3670016
    v_mov_b32 v48, 0
    v_mov_b32 v49, 0
    v_mov_b32 v50, 0
    v_mov_b32 v51, 0
    v_mov_b32 v52, 0
    v_mov_b32 v53, 0
    v_mov_b32 v54, 0
    v_mov_b32 v55, 0
    s_waitcnt vmcnt(14)
    v_perm_b32 v64, v196, v192, s12
    v_perm_b32 v68, v196, v192, s13
    v_perm_b32 v65, v197, v193, s12
    v_perm_b32 v69, v197, v193, s13
    v_perm_b32 v66, v198, v194, s12
    v_perm_b32 v70, v198, v194, s13
    v_perm_b32 v67, v199, v195, s12
    v_perm_b32 v71, v199, v195, s13
    s_waitcnt vmcnt(12)
    v_perm_b32 v72, v204, v200, s12
    v_perm_b32 v76, v204, v200, s13
    v_perm_b32 v73, v205, v201, s12
    v_perm_b32 v77, v205, v201, s13
    v_perm_b32 v74, v206, v202, s12
    v_perm_b32 v78, v206, v202, s13
    v_perm_b32 v75, v207, v203, s12
    v_perm_b32 v79, v207, v203, s13
    s_waitcnt vmcnt(10)
    v_perm_b32 v80, v212, v208, s12
    v_perm_b32 v84, v212, v208, s13
    v_perm_b32 v81, v213, v209, s12
    v_perm_b32 v85, v213, v209, s13
    v_perm_b32 v82, v214, v210, s12
    v_perm_b32 v86, v214, v210, s13
    v_perm_b32 v83, v215, v211, s12
    v_perm_b32 v87, v215, v211, s13
    s_waitcnt vmcnt(8)
    v_perm_b32 v88, v220, v216, s12
    v_perm_b32 v92, v220, v216, s13
    v_perm_b32 v89, v221, v217, s12
    v_perm_b32 v93, v221, v217, s13
    v_perm_b32 v90, v222, v218, s12
    v_perm_b32 v94, v222, v218, s13
    v_perm_b32 v91, v223, v219, s12
    v_perm_b32 v95, v223, v219, s13
    s_waitcnt vmcnt(6)
    v_perm_b32 v96, v228, v224, s12
    v_perm_b32 v100, v228, v224, s13
    v_perm_b32 v97, v229, v225, s12
    v_perm_b32 v101, v229, v225, s13
    v_perm_b32 v98, v230, v226, s12
    v_perm_b32 v102, v230, v226, s13
    v_perm_b32 v99, v231, v227, s12
    v_perm_b32 v103, v231, v227, s13
    s_waitcnt vmcnt(4)
    v_perm_b32 v104, v236, v232, s12
    v_perm_b32 v108, v236, v232, s13
    v_perm_b32 v105, v237, v233, s12
    v_perm_b32 v109, v237, v233, s13
    v_perm_b32 v106, v238, v234, s12
    v_perm_b32 v110, v238, v234, s13
    v_perm_b32 v107, v239, v235, s12
    v_perm_b32 v111, v239, v235, s13
    s_waitcnt vmcnt(2)
    v_perm_b32 v112, v244, v240, s12
    v_perm_b32 v116, v244, v240, s13
    v_perm_b32 v113, v245, v241, s12
    v_perm_b32 v117, v245, v241, s13
    v_perm_b32 v114, v246, v242, s12
    v_perm_b32 v118, v246, v242, s13
    v_perm_b32 v115, v247, v243, s12
    v_perm_b32 v119, v247, v243, s13
    s_waitcnt vmcnt(0)
    v_perm_b32 v120, v252, v248, s12
    v_perm_b32 v124, v252, v248, s13
    v_perm_b32 v121, v253, v249, s12
    v_perm_b32 v125, v253, v249, s13
    v_perm_b32 v122, v254, v250, s12
    v_perm_b32 v126, v254, v250, s13
    v_perm_b32 v123, v255, v251, s12
    v_perm_b32 v127, v255, v251, s13
    v_lshrrev_b32 v6, 5, v0
    v_lshlrev_b32 v6, 15, v6
    v_lshl_add_u32 v6, v60, 2, v6
    s_lshl_b32 s77, s16, 16
    s_lshl_b32 s98, s67, 9
    s_add_u32 s77, s77, s98
    s_lshl_b32 s97, s4, 12
    s_lshl_b32 s98, s67, 10
    s_add_u32 s98, s97, s98
    v_add_u32 v41, s98, v4
    s_lshl_b32 s96, s67, 3
    v_mov_b32 v42, s96
    s_cmp_lt_u32 s5, 14
    s_cselect_b32 s62, s62, 0
    s_cmp_lg_u32 s67, 0
    s_cbranch_scc1 L_svc_W
L_ldsw_106:
    ds_read_b32 v8, v7 offset:32
    s_waitcnt lgkmcnt(0)
    v_readfirstlane_b32 s96, v8
    s_nop 0
    s_cmp_ge_u32 s96, 1
    s_nop 1
    s_cbranch_scc1 L_ldsd_107
    s_sleep 8
    s_sub_u32 s76, s76, 1
    s_cmp_lg_u32 s76, 0
    s_cbranch_scc1 L_ldsw_106
    s_branch L_end
L_ldsd_107:
    s_lshl_b32 s97, s8, 12
    v_add_u32 v12, s97, v4
    s_nop 1
L_poll_108:
    s_mov_b32 s96, 0x1000
    buffer_load_dwordx4 v[16:19], v12, s[72:75], s96 offen sc1
    s_mov_b32 s96, 0x1400
    buffer_load_dwordx4 v[20:23], v12, s[72:75], s96 offen sc1
    s_mov_b32 s96, 0x1800
    buffer_load_dwordx4 v[24:27], v12, s[72:75], s96 offen sc1
    s_mov_b32 s96, 0x1c00
    buffer_load_dwordx4 v[28:31], v12, s[72:75], s96 offen sc1
    s_waitcnt vmcnt(0)
    v_xor_b32 v16, s10, v16
    v_xor_b32 v17, s10, v17
    v_xor_b32 v18, s10, v18
    v_xor_b32 v19, s10, v19
    v_xor_b32 v20, s10, v20
    v_xor_b32 v21, s10, v21
    v_xor_b32 v22, s10, v22
    v_xor_b32 v23, s10, v23
    v_xor_b32 v24, s10, v24
    v_xor_b32 v25, s10, v25
    v_xor_b32 v26, s10, v26
    v_xor_b32 v27, s10, v27
    v_xor_b32 v28, s10, v28
    v_xor_b32 v29, s10, v29
    v_xor_b32 v30, s10, v30
    v_xor_b32 v31, s10, v31
    v_or3_b32 v32, v16, v17, v18
    v_or3_b32 v33, v19, v20, v21
    v_or3_b32 v34, v22, v23, v24
    v_or3_b32 v35, v25, v26, v27
    v_or3_b32 v36, v28, v29, v30
    v_or3_b32 v32, v32, v33, v34
    v_or3_b32 v35, v35, v36, v31
    v_or_b32 v32, v32, v35
    v_and_b32 v32, 0xffff, v32
    v_cmp_ne_u32 s[100:101], 0, v32
    s_mov_b64 exec, -1
    s_cmp_lg_u64 s[100:101], 0
    s_nop 1
    s_cbranch_scc1 L_pollr_109
    v_lshrrev_b32 v9, 5, v0
    v_mul_u32_u24 v9, 272, v9
    v_and_b32 v10, 31, v0
    v_lshl_add_u32 v9, v10, 3, v9
    v_perm_b32 v32, v17, v16, s13
    v_perm_b32 v33, v19, v18, s13
    ds_write_b64 v9, v[32:33] offset:512
    v_perm_b32 v34, v21, v20, s13
    v_perm_b32 v35, v23, v22, s13
    ds_write_b64 v9, v[34:35] offset:1056
    v_perm_b32 v36, v25, v24, s13
    v_perm_b32 v37, v27, v26, s13
    ds_write_b64 v9, v[36:37] offset:1600
    v_perm_b32 v38, v29, v28, s13
    v_perm_b32 v39, v31, v30, s13
    ds_write_b64 v9, v[38:39] offset:2144
    v_mov_b32 v9, 1
    ds_write_b32 v7, v9 offset:4
    s_nop 0
L_ldsw_110:
    ds_read_b32 v8, v7 offset:8
    s_waitcnt lgkmcnt(0)
    v_readfirstlane_b32 s96, v8
    s_nop 0
    s_cmp_ge_u32 s96, 4
    s_nop 1
    s_cbranch_scc1 L_ldsd_111
    s_sleep 4
    s_sub_u32 s76, s76, 1
    s_cmp_lg_u32 s76, 0
    s_cbranch_scc1 L_ldsw_110
    s_branch L_end
L_ldsd_111:
    v_and_b32 v8, 7, v0
    v_lshlrev_b32 v8, 3, v8
    v_lshrrev_b32 v9, 3, v0
    v_lshl_add_u32 v8, v9, 7, v8
    ds_read_b64 v[16:17], v8 offset:3072
    ds_read_b64 v[18:19], v8 offset:3136
    s_waitcnt lgkmcnt(0)
    v_max_f32 v10, v16, v18
    s_nop 1
    v_max_f32_dpp v10, v10, v10 row_ror:8 row_mask:0xf bank_mask:0xf
    v_mov_b32 v22, v10
    s_nop 1
    v_permlane16_swap_b32 v22, v10
    v_max_f32 v10, v10, v22
    v_mov_b32 v22, v10
    s_nop 1
    v_permlane32_swap_b32 v22, v10
    v_max_f32 v10, v10, v22
    v_sub_f32 v16, v16, v10
    v_mul_f32 v16, s79, v16
    v_exp_f32 v16, v16
    v_sub_f32 v18, v18, v10
    v_mul_f32 v18, s79, v18
    v_exp_f32 v18, v18
    v_mul_f32 v11, v16, v17
    v_fmac_f32 v11, v18, v19
    s_nop 1
    v_add_f32_dpp v11, v11, v11 row_ror:8 row_mask:0xf bank_mask:0xf
    v_mov_b32 v22, v11
    s_nop 1
    v_permlane16_swap_b32 v22, v11
    v_add_f32 v11, v11, v22
    v_mov_b32 v22, v11
    s_nop 1
    v_permlane32_swap_b32 v22, v11
    v_add_f32 v11, v11, v22
    v_or_b32 v10, s11, v10
    v_add_u32 v11, 0x200, v11
    v_and_or_b32 v11, v11, s14, v5
    s_getreg_b32 s97, hwreg(HW_REG_XCC_ID, 0, 4)
    s_lshl_b32 s97, s97, 16
    s_or_b32 s23, s97, s11
    s_mov_b64 exec, 0xff00
    v_mov_b32 v10, s23
    v_mov_b32 v11, s23
    s_mov_b64 exec, -1
    v_lshlrev_b32 v8, 3, v0
    s_lshl_b32 s96, s6, 7
    s_add_u32 s96, s96, 32768
    s_mov_b64 exec, 0xffff
    buffer_store_dwordx2 v[10:11], v8, s[72:75], s96 offen sc1
    s_mov_b64 exec, -1
L_ldsw_112:
    ds_read_b32 v8, v7 offset:36
    s_waitcnt lgkmcnt(0)
    v_readfirstlane_b32 s96, v8
    s_nop 0
    s_cmp_ge_u32 s96, 1
    s_nop 1
    s_cbranch_scc1 L_ldsd_113
    s_sleep 8
    s_sub_u32 s76, s76, 1
    s_cmp_lg_u32 s76, 0
    s_cbranch_scc1 L_ldsw_112
    s_branch L_end
L_ldsd_113:
    v_lshrrev_b32 v12, 2, v0
    v_lshlrev_b32 v12, 7, v12
    v_and_b32 v13, 3, v0
    v_lshl_add_u32 v12, v13, 4, v12
    s_lshl_b32 s97, s8, 13
    v_add_u32 v12, s97, v12
    v_and_b32 v13, 31, v0
    v_lshlrev_b32 v13, 7, v13
    s_lshl_b32 s97, s4, 12
    v_add_u32 v13, s97, v13
    s_nop 1
L_poll_114:
    s_mov_b32 s96, 0x8000
    buffer_load_dwordx4 v[16:19], v12, s[72:75], s96 offen sc1
    s_mov_b32 s96, 0x8800
    buffer_load_dwordx4 v[20:23], v12, s[72:75], s96 offen sc1
    s_mov_b32 s96, 0x9000
    buffer_load_dwordx4 v[24:27], v12, s[72:75], s96 offen sc1
    s_mov_b32 s96, 0x9800
    buffer_load_dwordx4 v[28:31], v12, s[72:75], s96 offen sc1
    s_mov_b32 s96, 0x8040
    buffer_load_dwordx4 v[32:35], v13, s[72:75], s96 offen sc1
    s_waitcnt vmcnt(0)
    v_xor_b32 v16, s11, v16
    v_xor_b32 v17, s11, v17
    v_xor_b32 v18, s11, v18
    v_xor_b32 v19, s11, v19
    v_xor_b32 v20, s11, v20
    v_xor_b32 v21, s11, v21
    v_xor_b32 v22, s11, v22
    v_xor_b32 v23, s11, v23
    v_xor_b32 v24, s11, v24
    v_xor_b32 v25, s11, v25
    v_xor_b32 v26, s11, v26
    v_xor_b32 v27, s11, v27
    v_xor_b32 v28, s11, v28
    v_xor_b32 v29, s11, v29
    v_xor_b32 v30, s11, v30
    v_xor_b32 v31, s11, v31
    v_xor_b32 v32, s11, v32
    v_xor_b32 v33, s11, v33
    v_xor_b32 v34, s11, v34
    v_xor_b32 v35, s11, v35
    v_or3_b32 v236, v16, v17, v18
    v_or3_b32 v237, v19, v20, v21
    v_or3_b32 v238, v22, v23, v24
    v_or3_b32 v239, v25, v26, v27
    v_or3_b32 v240, v28, v29, v30
    v_or3_b32 v241, v31, v32, v33
    v_or_b32 v242, v34, v35
    v_or3_b32 v236, v236, v237, v238
    v_or3_b32 v239, v239, v240, v241
    v_or3_b32 v236, v236, v239, v242
    v_and_b32 v236, 0x3ff, v236
    v_cmp_ne_u32 s[100:101], 0, v236
    s_mov_b64 exec, -1
    s_cmp_lg_u64 s[100:101], 0
    s_nop 1
    s_cbranch_scc1 L_pollr_115
    s_andn2_b32 s97, s23, 0x3ff
    v_cmp_ne_u32 s[100:101], s97, v32
    s_nop 0
    s_cmp_eq_u64 s[100:101], 0
    s_cselect_b32 s97, 1, 0
    v_mov_b32 v32, s97
    ds_write_b32 v7, v32 offset:52
    v_max_f32 v236, v16, v20
    v_max3_f32 v236, v236, v24, v28
    v_max_f32 v238, v18, v22
    v_max3_f32 v238, v238, v26, v30
    v_max_f32_dpp v236, v236, v236 row_ror:8 row_mask:0xf bank_mask:0xf
    s_nop 1
    v_max_f32_dpp v236, v236, v236 row_ror:4 row_mask:0xf bank_mask:0xf
    v_mov_b32 v240, v236
    s_nop 1
    v_permlane16_swap_b32 v240, v236
    v_max_f32 v236, v236, v240
    v_mov_b32 v240, v236
    s_nop 1
    v_permlane32_swap_b32 v240, v236
    v_max_f32 v236, v236, v240
    v_max_f32_dpp v238, v238, v238 row_ror:8 row_mask:0xf bank_mask:0xf
    s_nop 1
    v_max_f32_dpp v238, v238, v238 row_ror:4 row_mask:0xf bank_mask:0xf
    v_mov_b32 v240, v238
    s_nop 1
    v_permlane16_swap_b32 v240, v238
    v_max_f32 v238, v238, v240
    v_mov_b32 v240, v238
    s_nop 1
    v_permlane32_swap_b32 v240, v238
    v_max_f32 v238, v238, v240
    v_sub_f32 v16, v16, v236
    v_mul_f32 v16, s79, v16
    v_exp_f32 v16, v16
    v_sub_f32 v20, v20, v236
    v_mul_f32 v20, s79, v20
    v_exp_f32 v20, v20
    v_sub_f32 v24, v24, v236
    v_mul_f32 v24, s79, v24
    v_exp_f32 v24, v24
    v_sub_f32 v28, v28, v236
    v_mul_f32 v28, s79, v28
    v_exp_f32 v28, v28
    v_mul_f32 v237, v16, v17
    v_fmac_f32 v237, v20, v21
    v_fmac_f32 v237, v24, v25
    v_fmac_f32 v237, v28, v29
    v_sub_f32 v18, v18, v238
    v_mul_f32 v18, s79, v18
    v_exp_f32 v18, v18
    v_sub_f32 v22, v22, v238
    v_mul_f32 v22, s79, v22
    v_exp_f32 v22, v22
    v_sub_f32 v26, v26, v238
    v_mul_f32 v26, s79, v26
    v_exp_f32 v26, v26
    v_sub_f32 v30, v30, v238
    v_mul_f32 v30, s79, v30
    v_exp_f32 v30, v30
    v_mul_f32 v239, v18, v19
    v_fmac_f32 v239, v22, v23
    v_fmac_f32 v239, v26, v27
    v_fmac_f32 v239, v30, v31
    v_add_f32_dpp v237, v237, v237 row_ror:8 row_mask:0xf bank_mask:0xf
    s_nop 1
    v_add_f32_dpp v237, v237, v237 row_ror:4 row_mask:0xf bank_mask:0xf
    v_mov_b32 v240, v237
    s_nop 1
    v_permlane16_swap_b32 v240, v237
    v_add_f32 v237, v237, v240
    v_mov_b32 v240, v237
    s_nop 1
    v_permlane32_swap_b32 v240, v237
    v_add_f32 v237, v237, v240
    v_rcp_f32 v237, v237
    v_add_f32_dpp v239, v239, v239 row_ror:8 row_mask:0xf bank_mask:0xf
    s_nop 1
    v_add_f32_dpp v239, v239, v239 row_ror:4 row_mask:0xf bank_mask:0xf
    v_mov_b32 v240, v239
    s_nop 1
    v_permlane16_swap_b32 v240, v239
    v_add_f32 v239, v239, v240
    v_mov_b32 v240, v239
    s_nop 1
    v_permlane32_swap_b32 v240, v239
    v_add_f32 v239, v239, v240
    v_rcp_f32 v239, v239
    v_and_b32 v8, 3, v0
    v_lshlrev_b32 v8, 4, v8
    ds_write_b128 v8, v[236:239] offset:5120
    v_and_b32 v8, 7, v0
    v_lshlrev_b32 v8, 3, v8
    v_bfe_u32 v10, v0, 3, 2
    v_lshl_add_u32 v10, v10, 8, v8
    ds_read_b64 v[16:17], v8 offset:5120
    ds_read_b32 v18, v10 offset:3072
    v_and_b32 v11, 31, v0
    v_lshlrev_b32 v11, 2, v11
    s_waitcnt lgkmcnt(0)
    v_sub_f32 v18, v18, v16
    v_mul_f32 v18, s79, v18
    v_exp_f32 v18, v18
    s_nop 0
    v_mul_f32 v18, v18, v17
    ds_write_b32 v11, v18 offset:5248
    v_mov_b32 v9, 1
    ds_write_b32 v7, v9 offset:12
    s_nop 0
L_svc_W:
L_ldsw_116:
    ds_read_b32 v8, v7 offset:12
    s_waitcnt lgkmcnt(0)
    v_readfirstlane_b32 s96, v8
    s_nop 0
    s_cmp_ge_u32 s96, 1
    s_nop 1
    s_cbranch_scc1 L_ldsd_117
    s_sleep 8
    s_sub_u32 s76, s76, 1
    s_cmp_lg_u32 s76, 0
    s_cbranch_scc1 L_ldsw_116
    s_branch L_end
L_ldsd_117:
    ds_read_b32 v8, v7 offset:52
    s_waitcnt lgkmcnt(0)
    v_readfirstlane_b32 s26, v8
    s_nop 4
L_ldsw_118:
    ds_read_b32 v8, v7 offset:16
    s_waitcnt lgkmcnt(0)
    v_readfirstlane_b32 s96, v8
    s_nop 0
    s_cmp_ge_u32 s96, 4
    s_nop 1
    s_cbranch_scc1 L_ldsd_119
    s_sleep 4
    s_sub_u32 s76, s76, 1
    s_cmp_lg_u32 s76, 0
    s_cbranch_scc1 L_ldsw_118
    s_branch L_end
L_ldsd_119:
    s_add_u32 s96, s77, 0
    buffer_load_dwordx4 v[192:195], v6, s[60:63], s96 offen offset:0 nt
    s_add_u32 s96, s77, 0
    buffer_load_dwordx4 v[196:199], v6, s[60:63], s96 offen offset:2048 nt
    s_add_u32 s96, s77, 4096
    buffer_load_dwordx4 v[200:203], v6, s[60:63], s96 offen offset:0 nt
    s_add_u32 s96, s77, 4096
    buffer_load_dwordx4 v[204:207], v6, s[60:63], s96 offen offset:2048 nt
    s_add_u32 s96, s77, 8192
    buffer_load_dwordx4 v[208:211], v6, s[60:63], s96 offen offset:0 nt
    s_add_u32 s96, s77, 8192
    buffer_load_dwordx4 v[212:215], v6, s[60:63], s96 offen offset:2048 nt
    s_mov_b32 s96, 0x200000
    buffer_load_dwordx4 v[176:179], v43, s[72:75], s96 offen sc1
    s_waitcnt vmcnt(5)
    v_perm_b32 v128, v196, v192, s12
    v_perm_b32 v132, v196, v192, s13
    v_perm_b32 v129, v197, v193, s12
    v_perm_b32 v133, v197, v193, s13
    v_perm_b32 v130, v198, v194, s12
    v_perm_b32 v134, v198, v194, s13
    v_perm_b32 v131, v199, v195, s12
    v_perm_b32 v135, v199, v195, s13
    s_waitcnt vmcnt(3)
    v_perm_b32 v136, v204, v200, s12
    v_perm_b32 v140, v204, v200, s13
    v_perm_b32 v137, v205, v201, s12
    v_perm_b32 v141, v205, v201, s13
    v_perm_b32 v138, v206, v202, s12
    v_perm_b32 v142, v206, v202, s13
    v_perm_b32 v139, v207, v203, s12
    v_perm_b32 v143, v207, v203, s13
    s_waitcnt vmcnt(1)
    v_perm_b32 v144, v212, v208, s12
    v_perm_b32 v148, v212, v208, s13
    v_perm_b32 v145, v213, v209, s12
    v_perm_b32 v149, v213, v209, s13
    v_perm_b32 v146, v214, v210, s12
    v_perm_b32 v150, v214, v210, s13
    v_perm_b32 v147, v215, v211, s12
    v_perm_b32 v151, v215, v211, s13
    s_nop 1
L_ldsw_120:
    ds_read_b32 v8, v7 offset:28
    s_waitcnt lgkmcnt(0)
    v_readfirstlane_b32 s96, v8
    s_nop 0
    s_cmp_ge_u32 s96, 4
    s_nop 1
    s_cbranch_scc1 L_ldsd_121
    s_sleep 2
    s_sub_u32 s76, s76, 1
    s_cmp_lg_u32 s76, 0
    s_cbranch_scc1 L_ldsw_120
    s_branch L_end
L_ldsd_121:
    s_mov_b64 exec, 0xff
    v_mov_b32 v24, s11
    s_nop 1
L_a1:
    s_mov_b32 s96, 0x100000
    buffer_load_dwordx4 v[16:19], v56, s[72:75], s96 offen sc1
    s_waitcnt vmcnt(0)
    v_bitop3_b32 v20, v16, v17, v24 bitop3:0x7e
    v_and_b32 v20, 0x3ff, v20
    v_cmp_ne_u32 s[100:101], 0, v20
    s_nop 0
    s_cmp_eq_u64 s[100:101], 0
    s_nop 1
    s_cbranch_scc1 L_a1d
    s_sleep 4
    s_sub_u32 s76, s76, 1
    s_cmp_lg_u32 s76, 0
    s_cbranch_scc1 L_a1
L_a1d:
    s_mov_b64 exec, -1
L_poll_122:
    s_mov_b32 s96, 0x100000
    buffer_load_dwordx4 v[16:19], v56, s[72:75], s96 offen sc1
    s_mov_b32 s96, 0x108000
    buffer_load_dwordx4 v[20:23], v56, s[72:75], s96 offen sc1
    s_waitcnt vmcnt(0)
    v_xor_b32 v16, s11, v16
    v_xor_b32 v17, s11, v17
    v_xor_b32 v18, s11, v18
    v_xor_b32 v19, s11, v19
    v_xor_b32 v20, s11, v20
    v_xor_b32 v21, s11, v21
    v_xor_b32 v22, s11, v22
    v_xor_b32 v23, s11, v23
    v_or3_b32 v24, v16, v17, v18
    v_or3_b32 v25, v19, v20, v21
    v_or_b32 v26, v22, v23
    v_or3_b32 v24, v24, v25, v26
    v_and_b32 v24, 0x3ff, v24
    v_cmp_ne_u32 s[100:101], 0, v24
    s_mov_b64 exec, -1
    s_cmp_lg_u64 s[100:101], 0
    s_nop 1
    s_cbranch_scc1 L_pollr_123
    v_pk_add_f32 v[16:17], v[16:17], v[20:21]
    v_pk_add_f32 v[18:19], v[18:19], v[22:23]
    s_nop 1
    v_permlane32_swap_b32 v16, v18
    v_permlane32_swap_b32 v17, v19
    v_pk_add_f32 v[16:17], v[16:17], v[18:19]
    s_nop 1
    v_permlane16_swap_b32 v16, v17
    v_add_f32 v16, v16, v17
    s_nop 1
    v_add_f32_dpp v16, v16, v16 row_ror:8 row_mask:0xf bank_mask:0xf
    ds_write_b32 v57, v16 offset:8192
    s_waitcnt lgkmcnt(0)
    s_barrier
    ds_read2_b32 v[16:17], v58 offset0:0 offset1:32
    ds_read2_b32 v[18:19], v58 offset0:64 offset1:96
    s_waitcnt lgkmcnt(0)
    v_add_f32 v16, v16, v17
    v_add_f32 v18, v18, v19
    v_add_f32 v16, v16, v18
    s_nop 1
    v_mov_b32_dpp v20, v16 quad_perm:[1,0,3,2] row_mask:0xf bank_mask:0xf
    v_cvt_pk_bf16_f32 v20, v16, v20
    s_nop 1
    v_dot2c_f32_bf16_dpp v48, v20, v64 row_newbcast:0 row_mask:0xf bank_mask:0xf
    v_dot2c_f32_bf16_dpp v49, v20, v68 row_newbcast:0 row_mask:0xf bank_mask:0xf
    v_dot2c_f32_bf16_dpp v50, v20, v65 row_newbcast:0 row_mask:0xf bank_mask:0xf
    v_dot2c_f32_bf16_dpp v51, v20, v69 row_newbcast:0 row_mask:0xf bank_mask:0xf
    v_dot2c_f32_bf16_dpp v52, v20, v66 row_newbcast:0 row_mask:0xf bank_mask:0xf
    v_dot2c_f32_bf16_dpp v53, v20, v70 row_newbcast:0 row_mask:0xf bank_mask:0xf
    v_dot2c_f32_bf16_dpp v54, v20, v67 row_newbcast:0 row_mask:0xf bank_mask:0xf
    v_dot2c_f32_bf16_dpp v55, v20, v71 row_newbcast:0 row_mask:0xf bank_mask:0xf
    v_dot2c_f32_bf16_dpp v48, v20, v72 row_newbcast:2 row_mask:0xf bank_mask:0xf
    v_dot2c_f32_bf16_dpp v49, v20, v76 row_newbcast:2 row_mask:0xf bank_mask:0xf
    v_dot2c_f32_bf16_dpp v50, v20, v73 row_newbcast:2 row_mask:0xf bank_mask:0xf
    v_dot2c_f32_bf16_dpp v51, v20, v77 row_newbcast:2 row_mask:0xf bank_mask:0xf
    v_dot2c_f32_bf16_dpp v52, v20, v74 row_newbcast:2 row_mask:0xf bank_mask:0xf
    v_dot2c_f32_bf16_dpp v53, v20, v78 row_newbcast:2 row_mask:0xf bank_mask:0xf
    v_dot2c_f32_bf16_dpp v54, v20, v75 row_newbcast:2 row_mask:0xf bank_mask:0xf
    v_dot2c_f32_bf16_dpp v55, v20, v79 row_newbcast:2 row_mask:0xf bank_mask:0xf
    v_dot2c_f32_bf16_dpp v48, v20, v80 row_newbcast:4 row_mask:0xf bank_mask:0xf
    v_dot2c_f32_bf16_dpp v49, v20, v84 row_newbcast:4 row_mask:0xf bank_mask:0xf
    v_dot2c_f32_bf16_dpp v50, v20, v81 row_newbcast:4 row_mask:0xf bank_mask:0xf
    v_dot2c_f32_bf16_dpp v51, v20, v85 row_newbcast:4 row_mask:0xf bank_mask:0xf
    v_dot2c_f32_bf16_dpp v52, v20, v82 row_newbcast:4 row_mask:0xf bank_mask:0xf
    v_dot2c_f32_bf16_dpp v53, v20, v86 row_newbcast:4 row_mask:0xf bank_mask:0xf
    v_dot2c_f32_bf16_dpp v54, v20, v83 row_newbcast:4 row_mask:0xf bank_mask:0xf
    v_dot2c_f32_bf16_dpp v55, v20, v87 row_newbcast:4 row_mask:0xf bank_mask:0xf
    v_dot2c_f32_bf16_dpp v48, v20, v88 row_newbcast:6 row_mask:0xf bank_mask:0xf
    v_dot2c_f32_bf16_dpp v49, v20, v92 row_newbcast:6 row_mask:0xf bank_mask:0xf
    v_dot2c_f32_bf16_dpp v50, v20, v89 row_newbcast:6 row_mask:0xf bank_mask:0xf
    v_dot2c_f32_bf16_dpp v51, v20, v93 row_newbcast:6 row_mask:0xf bank_mask:0xf
    v_dot2c_f32_bf16_dpp v52, v20, v90 row_newbcast:6 row_mask:0xf bank_mask:0xf
    v_dot2c_f32_bf16_dpp v53, v20, v94 row_newbcast:6 row_mask:0xf bank_mask:0xf
    v_dot2c_f32_bf16_dpp v54, v20, v91 row_newbcast:6 row_mask:0xf bank_mask:0xf
    v_dot2c_f32_bf16_dpp v55, v20, v95 row_newbcast:6 row_mask:0xf bank_mask:0xf
    v_dot2c_f32_bf16_dpp v48, v20, v96 row_newbcast:8 row_mask:0xf bank_mask:0xf
    v_dot2c_f32_bf16_dpp v49, v20, v100 row_newbcast:8 row_mask:0xf bank_mask:0xf
    v_dot2c_f32_bf16_dpp v50, v20, v97 row_newbcast:8 row_mask:0xf bank_mask:0xf
    v_dot2c_f32_bf16_dpp v51, v20, v101 row_newbcast:8 row_mask:0xf bank_mask:0xf
    v_dot2c_f32_bf16_dpp v52, v20, v98 row_newbcast:8 row_mask:0xf bank_mask:0xf
    v_dot2c_f32_bf16_dpp v53, v20, v102 row_newbcast:8 row_mask:0xf bank_mask:0xf
    v_dot2c_f32_bf16_dpp v54, v20, v99 row_newbcast:8 row_mask:0xf bank_mask:0xf
    v_dot2c_f32_bf16_dpp v55, v20, v103 row_newbcast:8 row_mask:0xf bank_mask:0xf
    v_dot2c_f32_bf16_dpp v48, v20, v104 row_newbcast:10 row_mask:0xf bank_mask:0xf
    v_dot2c_f32_bf16_dpp v49, v20, v108 row_newbcast:10 row_mask:0xf bank_mask:0xf
    v_dot2c_f32_bf16_dpp v50, v20, v105 row_newbcast:10 row_mask:0xf bank_mask:0xf
    v_dot2c_f32_bf16_dpp v51, v20, v109 row_newbcast:10 row_mask:0xf bank_mask:0xf
    v_dot2c_f32_bf16_dpp v52, v20, v106 row_newbcast:10 row_mask:0xf bank_mask:0xf
    v_dot2c_f32_bf16_dpp v53, v20, v110 row_newbcast:10 row_mask:0xf bank_mask:0xf
    v_dot2c_f32_bf16_dpp v54, v20, v107 row_newbcast:10 row_mask:0xf bank_mask:0xf
    v_dot2c_f32_bf16_dpp v55, v20, v111 row_newbcast:10 row_mask:0xf bank_mask:0xf
    v_dot2c_f32_bf16_dpp v48, v20, v112 row_newbcast:12 row_mask:0xf bank_mask:0xf
    v_dot2c_f32_bf16_dpp v49, v20, v116 row_newbcast:12 row_mask:0xf bank_mask:0xf
    v_dot2c_f32_bf16_dpp v50, v20, v113 row_newbcast:12 row_mask:0xf bank_mask:0xf
    v_dot2c_f32_bf16_dpp v51, v20, v117 row_newbcast:12 row_mask:0xf bank_mask:0xf
    v_dot2c_f32_bf16_dpp v52, v20, v114 row_newbcast:12 row_mask:0xf bank_mask:0xf
    v_dot2c_f32_bf16_dpp v53, v20, v118 row_newbcast:12 row_mask:0xf bank_mask:0xf
    v_dot2c_f32_bf16_dpp v54, v20, v115 row_newbcast:12 row_mask:0xf bank_mask:0xf
    v_dot2c_f32_bf16_dpp v55, v20, v119 row_newbcast:12 row_mask:0xf bank_mask:0xf
    v_dot2c_f32_bf16_dpp v48, v20, v120 row_newbcast:14 row_mask:0xf bank_mask:0xf
    v_dot2c_f32_bf16_dpp v49, v20, v124 row_newbcast:14 row_mask:0xf bank_mask:0xf
    v_dot2c_f32_bf16_dpp v50, v20, v121 row_newbcast:14 row_mask:0xf bank_mask:0xf
    v_dot2c_f32_bf16_dpp v51, v20, v125 row_newbcast:14 row_mask:0xf bank_mask:0xf
    v_dot2c_f32_bf16_dpp v52, v20, v122 row_newbcast:14 row_mask:0xf bank_mask:0xf
    v_dot2c_f32_bf16_dpp v53, v20, v126 row_newbcast:14 row_mask:0xf bank_mask:0xf
    v_dot2c_f32_bf16_dpp v54, v20, v123 row_newbcast:14 row_mask:0xf bank_mask:0xf
    v_dot2c_f32_bf16_dpp v55, v20, v127 row_newbcast:14 row_mask:0xf bank_mask:0xf
    v_permlane32_swap_b32 v48, v52
    v_permlane32_swap_b32 v49, v53
    v_permlane32_swap_b32 v50, v54
    v_permlane32_swap_b32 v51, v55
    v_pk_add_f32 v[48:49], v[48:49], v[52:53]
    v_pk_add_f32 v[50:51], v[50:51], v[54:55]
    v_add_u32 v48, 0x200, v48
    v_and_or_b32 v48, v48, s14, v5
    v_add_u32 v49, 0x200, v49
    v_and_or_b32 v49, v49, s14, v5
    v_add_u32 v50, 0x200, v50
    v_and_or_b32 v50, v50, s14, v5
    v_add_u32 v51, 0x200, v51
    v_and_or_b32 v51, v51, s14, v5
    s_cmp_eq_u32 s26, 0
    s_cbranch_scc1 L_sl_124
    buffer_store_dwordx4 v[48:51], v15, s[72:75], s66 offen
    s_nop 0
    s_branch L_sl_125
L_sl_124:
    buffer_store_dwordx4 v[48:51], v15, s[72:75], s66 offen sc1
    s_nop 1
L_sl_125:
L_poll_126:
    s_mov_b32 s96, 0x200000
    buffer_load_dwordx4 v[16:19], v43, s[72:75], s96 offen sc1
    s_waitcnt vmcnt(0)
    v_xor_b32 v16, s11, v16
    v_xor_b32 v17, s11, v17
    v_xor_b32 v18, s11, v18
    v_xor_b32 v19, s11, v19
    v_or3_b32 v24, v16, v17, v18
    v_or_b32 v24, v24, v19
    v_and_b32 v24, 0x3ff, v24
    v_cmp_ne_u32 s[100:101], 0, v24
    s_mov_b64 exec, -1
    s_cmp_lg_u64 s[100:101], 0
    s_nop 1
    s_cbranch_scc1 L_pollr_127
    v_permlane32_swap_b32 v16, v18
    v_permlane32_swap_b32 v17, v19
    v_pk_add_f32 v[16:17], v[16:17], v[18:19]
    s_nop 1
    v_permlane16_swap_b32 v16, v17
    v_add_f32 v16, v16, v17
    ds_write_b32 v63, v16 offset:12288
    v_lshlrev_b32 v10, 4, v1
    s_waitcnt lgkmcnt(0)
    s_barrier
    ds_read_b128 v[16:19], v10 offset:12288
    ds_read_b128 v[20:23], v10 offset:12544
    ds_read_b128 v[24:27], v10 offset:12800
    ds_read_b128 v[28:31], v10 offset:13056
    s_waitcnt lgkmcnt(0)
    v_pk_add_f32 v[16:17], v[16:17], v[20:21]
    v_pk_add_f32 v[18:19], v[18:19], v[22:23]
    v_pk_add_f32 v[24:25], v[24:25], v[28:29]
    v_pk_add_f32 v[26:27], v[26:27], v[30:31]
    v_pk_add_f32 v[16:17], v[16:17], v[24:25]
    v_pk_add_f32 v[18:19], v[18:19], v[26:27]
    v_add_u32 v16, 0x200, v16
    v_and_or_b32 v16, v16, s14, v5
    v_add_u32 v17, 0x200, v17
    v_and_or_b32 v17, v17, s14, v5
    v_add_u32 v18, 0x200, v18
    v_and_or_b32 v18, v18, s14, v5
    v_add_u32 v19, 0x200, v19
    v_and_or_b32 v19, v19, s14, v5
    s_mov_b32 exec_lo, 0xffff
    s_mov_b32 exec_hi, 0xffff
    buffer_store_dwordx4 v[16:19], v45, s[72:75], s20 offen sc1
    s_mov_b64 exec, -1
    s_add_u32 s96, s77, 12288
    buffer_load_dwordx4 v[216:219], v6, s[60:63], s96 offen offset:0 nt
    s_add_u32 s96, s77, 12288
    buffer_load_dwordx4 v[220:223], v6, s[60:63], s96 offen offset:2048 nt
    s_add_u32 s96, s77, 16384
    buffer_load_dwordx4 v[224:227], v6, s[60:63], s96 offen offset:0 nt
    s_add_u32 s96, s77, 16384
    buffer_load_dwordx4 v[228:231], v6, s[60:63], s96 offen offset:2048 nt
    s_add_u32 s96, s77, 20480
    buffer_load_dwordx4 v[232:235], v6, s[60:63], s96 offen offset:0 nt
    s_add_u32 s96, s77, 20480
    buffer_load_dwordx4 v[236:239], v6, s[60:63], s96 offen offset:2048 nt
    s_add_u32 s96, s77, 24576
    buffer_load_dwordx4 v[240:243], v6, s[60:63], s96 offen offset:0 nt
    s_add_u32 s96, s77, 24576
    buffer_load_dwordx4 v[244:247], v6, s[60:63], s96 offen offset:2048 nt
    s_add_u32 s96, s77, 28672
    buffer_load_dwordx4 v[248:251], v6, s[60:63], s96 offen offset:0 nt
    s_add_u32 s96, s77, 28672
    buffer_load_dwordx4 v[252:255], v6, s[60:63], s96 offen offset:2048 nt
    s_mov_b32 s96, 0x10000
    buffer_load_dwordx4 v[112:115], v41, s[72:75], s96 offen sc1
    s_mov_b32 s96, 0x500000
    buffer_load_dwordx4 v[116:119], v61, s[72:75], s96 offen sc1
    s_mov_b32 s96, 0x580000
    buffer_load_dwordx4 v[120:123], v61, s[72:75], s96 offen sc1
    s_add_u32 s66, s66, 1048576
    s_cmp_ge_u32 s5, 14
    s_cbranch_scc1 L_final0
    s_waitcnt vmcnt(11)
    v_perm_b32 v152, v220, v216, s12
    v_perm_b32 v156, v220, v216, s13
    v_perm_b32 v153, v221, v217, s12
    v_perm_b32 v157, v221, v217, s13
    v_perm_b32 v154, v222, v218, s12
    v_perm_b32 v158, v222, v218, s13
    v_perm_b32 v155, v223, v219, s12
    v_perm_b32 v159, v223, v219, s13
    s_waitcnt vmcnt(9)
    v_perm_b32 v160, v228, v224, s12
    v_perm_b32 v164, v228, v224, s13
    v_perm_b32 v161, v229, v225, s12
    v_perm_b32 v165, v229, v225, s13
    v_perm_b32 v162, v230, v226, s12
    v_perm_b32 v166, v230, v226, s13
    v_perm_b32 v163, v231, v227, s12
    v_perm_b32 v167, v231, v227, s13
    s_waitcnt vmcnt(7)
    v_perm_b32 v168, v236, v232, s12
    v_perm_b32 v172, v236, v232, s13
    v_perm_b32 v169, v237, v233, s12
    v_perm_b32 v173, v237, v233, s13
    v_perm_b32 v170, v238, v234, s12
    v_perm_b32 v174, v238, v234, s13
    v_perm_b32 v171, v239, v235, s12
    v_perm_b32 v175, v239, v235, s13
    s_waitcnt vmcnt(5)
    v_perm_b32 v176, v244, v240, s12
    v_perm_b32 v180, v244, v240, s13
    v_perm_b32 v177, v245, v241, s12
    v_perm_b32 v181, v245, v241, s13
    v_perm_b32 v178, v246, v242, s12
    v_perm_b32 v182, v246, v242, s13
    v_perm_b32 v179, v247, v243, s12
    v_perm_b32 v183, v247, v243, s13
    s_waitcnt vmcnt(3)
    v_perm_b32 v184, v252, v248, s12
    v_perm_b32 v188, v252, v248, s13
    v_perm_b32 v185, v253, v249, s12
    v_perm_b32 v189, v253, v249, s13
    v_perm_b32 v186, v254, v250, s12
    v_perm_b32 v190, v254, v250, s13
    v_perm_b32 v187, v255, v251, s12
    v_perm_b32 v191, v255, v251, s13
    v_mov_b32 v48, 0
    v_mov_b32 v49, 0
    v_mov_b32 v50, 0
    v_mov_b32 v51, 0
    v_mov_b32 v52, 0
    v_mov_b32 v53, 0
    v_mov_b32 v54, 0
    v_mov_b32 v55, 0
    s_nop 1
L_poll_128:
    s_mov_b32 s96, 0x10000
    buffer_load_dwordx4 v[64:67], v41, s[72:75], s96 offen sc1
    s_waitcnt vmcnt(0)
    v_xor_b32 v64, s10, v64
    v_xor_b32 v65, s10, v65
    v_xor_b32 v66, s10, v66
    v_xor_b32 v67, s10, v67
    v_or3_b32 v72, v64, v65, v66
    v_or_b32 v72, v72, v67
    v_and_b32 v72, 0xffff, v72
    v_cmp_ne_u32 s[100:101], 0, v72
    s_mov_b64 exec, -1
    s_cmp_lg_u64 s[100:101], 0
    s_nop 1
    s_cbranch_scc1 L_pollr_129
    s_mov_b32 s96, 0x500000
    buffer_load_dwordx4 v[16:19], v61, s[72:75], s96 offen sc1
    s_mov_b32 s96, 0x580000
    buffer_load_dwordx4 v[20:23], v61, s[72:75], s96 offen sc1
    v_readfirstlane_b32 s97, v64
    s_nop 1
    v_subrev_f32 v64, s97, v64
    v_subrev_f32 v65, s97, v65
    v_subrev_f32 v66, s97, v66
    v_subrev_f32 v67, s97, v67
    v_add_f32 v72, v64, v65
    v_mul_f32 v73, v64, v64
    v_add_f32 v74, v66, v67
    v_fmac_f32 v73, v65, v65
    v_add_f32 v72, v72, v74
    v_fmac_f32 v73, v66, v66
    v_fmac_f32 v73, v67, v67
    s_nop 1
    v_permlane32_swap_b32 v72, v73
    v_add_f32 v72, v72, v73
    s_nop 1
    v_add_f32_dpp v72, v72, v72 row_ror:8 row_mask:0xf bank_mask:0xf
    s_nop 1
    v_add_f32_dpp v72, v72, v72 row_ror:4 row_mask:0xf bank_mask:0xf
    s_nop 1
    v_add_f32_dpp v72, v72, v72 row_ror:2 row_mask:0xf bank_mask:0xf
    s_nop 1
    v_add_f32_dpp v72, v72, v72 row_ror:1 row_mask:0xf bank_mask:0xf
    v_mov_b32 v74, v72
    s_nop 1
    v_permlane16_swap_b32 v74, v72
    v_add_f32 v72, v72, v74
    v_mov_b32 v73, v72
    s_nop 1
    v_permlane32_swap_b32 v72, v73
    v_mul_f32 v74, 0x3b800000, v72
    v_fma_f32 v73, -v74, v72, v73
    v_add_f32 v72, s97, v74
    ds_write_b64 v42, v[72:73] offset:6144
    s_branch L_eentry
L_poll_130:
    s_mov_b32 s96, 0x500000
    buffer_load_dwordx4 v[16:19], v61, s[72:75], s96 offen sc1
    s_mov_b32 s96, 0x580000
    buffer_load_dwordx4 v[20:23], v61, s[72:75], s96 offen sc1
L_eentry:
    s_waitcnt vmcnt(0)
    v_xor_b32 v16, s11, v16
    v_xor_b32 v17, s11, v17
    v_xor_b32 v18, s11, v18
    v_xor_b32 v19, s11, v19
    v_xor_b32 v20, s11, v20
    v_xor_b32 v21, s11, v21
    v_xor_b32 v22, s11, v22
    v_xor_b32 v23, s11, v23
    v_or3_b32 v24, v16, v17, v18
    v_or3_b32 v25, v19, v20, v21
    v_or_b32 v26, v22, v23
    v_or3_b32 v24, v24, v25, v26
    v_and_b32 v24, 0x3ff, v24
    v_cmp_ne_u32 s[100:101], 0, v24
    s_mov_b64 exec, -1
    s_cmp_lg_u64 s[100:101], 0
    s_nop 1
    s_cbranch_scc1 L_pollr_131
    v_permlane32_swap_b32 v16, v18
    v_permlane32_swap_b32 v17, v19
    v_permlane32_swap_b32 v20, v22
    v_permlane32_swap_b32 v21, v23
    v_pk_add_f32 v[16:17], v[16:17], v[18:19]
    v_pk_add_f32 v[20:21], v[20:21], v[22:23]
    s_nop 0
    v_permlane16_swap_b32 v16, v17
    v_permlane16_swap_b32 v20, v21
    v_add_f32 v16, v16, v17
    v_add_f32 v20, v20, v21
    s_nop 0
    v_add_f32_dpp v16, v16, v16 row_ror:8 row_mask:0xf bank_mask:0xf
    v_add_f32_dpp v20, v20, v20 row_ror:8 row_mask:0xf bank_mask:0xf
    ds_write_b32 v57, v16 offset:9216
    ds_write_b32 v57, v20 offset:9728
    s_waitcnt lgkmcnt(0)
    s_barrier
    ds_read_b128 v[76:79], v7 offset:6144
    ds_read_b128 v[80:83], v7 offset:6160
    ds_read2_b32 v[16:17], v62 offset0:0 offset1:32
    ds_read2_b32 v[20:21], v62 offset0:128 offset1:160
    ds_read2_b32 v[18:19], v62 offset0:64 offset1:96
    ds_read2_b32 v[22:23], v62 offset0:192 offset1:224
    s_waitcnt lgkmcnt(4)
    v_pk_add_f32 v[72:73], v[76:77], v[78:79]
    v_pk_add_f32 v[74:75], v[80:81], v[82:83]
    v_pk_add_f32 v[72:73], v[72:73], v[74:75]
    v_mul_f32 v72, 0x3e800000, v72
    v_mul_f32 v73, 0x3b800000, v73
    v_sub_f32 v76, v76, v72
    v_sub_f32 v78, v78, v72
    v_sub_f32 v80, v80, v72
    v_sub_f32 v82, v82, v72
    v_fmac_f32 v73, v76, v76
    v_fmac_f32 v73, v78, v78
    v_fmac_f32 v73, v80, v80
    v_fmac_f32 v73, v82, v82
    v_mul_f32 v73, 0x3e800000, v73
    v_cvt_pk_bf16_f32 v86, v72, v72
    v_and_b32 v86, s15, v86
    v_cvt_pk_bf16_f32 v73, v73, v73
    v_and_b32 v73, s15, v73
    v_add_f32 v73, 0x3727c5ac, v73
    v_cvt_pk_bf16_f32 v73, v73, v73
    v_and_b32 v73, s15, v73
    v_sqrt_f32 v73, v73
    s_nop 0
    v_cvt_pk_bf16_f32 v73, v73, v73
    v_and_b32 v73, s15, v73
    v_rcp_f32 v87, v73
    s_waitcnt lgkmcnt(0)
    v_add_f32 v16, v16, v17
    v_add_f32 v18, v18, v19
    v_add_f32 v20, v20, v21
    v_add_f32 v22, v22, v23
    v_fma_f32 v16, -v86, v20, v16
    v_fma_f32 v18, -v86, v22, v18
    v_mul_f32 v16, v16, v87
    v_mul_f32 v18, v18, v87
    v_cvt_pk_bf16_f32 v16, v16, v16
    v_and_b32 v16, s15, v16
    v_cvt_pk_bf16_f32 v18, v18, v18
    v_and_b32 v18, s15, v18
    v_mul_f32 v17, v16, v16
    v_mul_f32 v17, v17, v16
    v_mov_b32 v19, v16
    v_fmac_f32 v19, 0x3d372713, v17
    v_mul_f32 v19, 0xc0135761, v19
    v_exp_f32 v19, v19
    s_nop 0
    v_add_f32 v19, 1.0, v19
    v_rcp_f32 v19, v19
    s_nop 0
    v_mul_f32 v16, v16, v19
    v_cvt_pk_bf16_f32 v16, v16, v16
    v_and_b32 v16, s15, v16
    v_mul_f32 v16, v16, v18
    s_nop 1
    v_mov_b32_dpp v20, v16 quad_perm:[1,0,3,2] row_mask:0xf bank_mask:0xf
    v_cvt_pk_bf16_f32 v20, v16, v20
    s_nop 1
    v_dot2c_f32_bf16_dpp v48, v20, v128 row_newbcast:0 row_mask:0xf bank_mask:0xf
    v_dot2c_f32_bf16_dpp v49, v20, v132 row_newbcast:0 row_mask:0xf bank_mask:0xf
    v_dot2c_f32_bf16_dpp v50, v20, v129 row_newbcast:0 row_mask:0xf bank_mask:0xf
    v_dot2c_f32_bf16_dpp v51, v20, v133 row_newbcast:0 row_mask:0xf bank_mask:0xf
    v_dot2c_f32_bf16_dpp v52, v20, v130 row_newbcast:0 row_mask:0xf bank_mask:0xf
    v_dot2c_f32_bf16_dpp v53, v20, v134 row_newbcast:0 row_mask:0xf bank_mask:0xf
    v_dot2c_f32_bf16_dpp v54, v20, v131 row_newbcast:0 row_mask:0xf bank_mask:0xf
    v_dot2c_f32_bf16_dpp v55, v20, v135 row_newbcast:0 row_mask:0xf bank_mask:0xf
    v_dot2c_f32_bf16_dpp v48, v20, v136 row_newbcast:2 row_mask:0xf bank_mask:0xf
    v_dot2c_f32_bf16_dpp v49, v20, v140 row_newbcast:2 row_mask:0xf bank_mask:0xf
    v_dot2c_f32_bf16_dpp v50, v20, v137 row_newbcast:2 row_mask:0xf bank_mask:0xf
    v_dot2c_f32_bf16_dpp v51, v20, v141 row_newbcast:2 row_mask:0xf bank_mask:0xf
    v_dot2c_f32_bf16_dpp v52, v20, v138 row_newbcast:2 row_mask:0xf bank_mask:0xf
    v_dot2c_f32_bf16_dpp v53, v20, v142 row_newbcast:2 row_mask:0xf bank_mask:0xf
    v_dot2c_f32_bf16_dpp v54, v20, v139 row_newbcast:2 row_mask:0xf bank_mask:0xf
    v_dot2c_f32_bf16_dpp v55, v20, v143 row_newbcast:2 row_mask:0xf bank_mask:0xf
    v_dot2c_f32_bf16_dpp v48, v20, v144 row_newbcast:4 row_mask:0xf bank_mask:0xf
    v_dot2c_f32_bf16_dpp v49, v20, v148 row_newbcast:4 row_mask:0xf bank_mask:0xf
    v_dot2c_f32_bf16_dpp v50, v20, v145 row_newbcast:4 row_mask:0xf bank_mask:0xf
    v_dot2c_f32_bf16_dpp v51, v20, v149 row_newbcast:4 row_mask:0xf bank_mask:0xf
    v_dot2c_f32_bf16_dpp v52, v20, v146 row_newbcast:4 row_mask:0xf bank_mask:0xf
    v_dot2c_f32_bf16_dpp v53, v20, v150 row_newbcast:4 row_mask:0xf bank_mask:0xf
    v_dot2c_f32_bf16_dpp v54, v20, v147 row_newbcast:4 row_mask:0xf bank_mask:0xf
    v_dot2c_f32_bf16_dpp v55, v20, v151 row_newbcast:4 row_mask:0xf bank_mask:0xf
    v_dot2c_f32_bf16_dpp v48, v20, v152 row_newbcast:6 row_mask:0xf bank_mask:0xf
    v_dot2c_f32_bf16_dpp v49, v20, v156 row_newbcast:6 row_mask:0xf bank_mask:0xf
    v_dot2c_f32_bf16_dpp v50, v20, v153 row_newbcast:6 row_mask:0xf bank_mask:0xf
    v_dot2c_f32_bf16_dpp v51, v20, v157 row_newbcast:6 row_mask:0xf bank_mask:0xf
    v_dot2c_f32_bf16_dpp v52, v20, v154 row_newbcast:6 row_mask:0xf bank_mask:0xf
    v_dot2c_f32_bf16_dpp v53, v20, v158 row_newbcast:6 row_mask:0xf bank_mask:0xf
    v_dot2c_f32_bf16_dpp v54, v20, v155 row_newbcast:6 row_mask:0xf bank_mask:0xf
    v_dot2c_f32_bf16_dpp v55, v20, v159 row_newbcast:6 row_mask:0xf bank_mask:0xf
    v_dot2c_f32_bf16_dpp v48, v20, v160 row_newbcast:8 row_mask:0xf bank_mask:0xf
    v_dot2c_f32_bf16_dpp v49, v20, v164 row_newbcast:8 row_mask:0xf bank_mask:0xf
    v_dot2c_f32_bf16_dpp v50, v20, v161 row_newbcast:8 row_mask:0xf bank_mask:0xf
    v_dot2c_f32_bf16_dpp v51, v20, v165 row_newbcast:8 row_mask:0xf bank_mask:0xf
    v_dot2c_f32_bf16_dpp v52, v20, v162 row_newbcast:8 row_mask:0xf bank_mask:0xf
    v_dot2c_f32_bf16_dpp v53, v20, v166 row_newbcast:8 row_mask:0xf bank_mask:0xf
    v_dot2c_f32_bf16_dpp v54, v20, v163 row_newbcast:8 row_mask:0xf bank_mask:0xf
    v_dot2c_f32_bf16_dpp v55, v20, v167 row_newbcast:8 row_mask:0xf bank_mask:0xf
    v_dot2c_f32_bf16_dpp v48, v20, v168 row_newbcast:10 row_mask:0xf bank_mask:0xf
    v_dot2c_f32_bf16_dpp v49, v20, v172 row_newbcast:10 row_mask:0xf bank_mask:0xf
    v_dot2c_f32_bf16_dpp v50, v20, v169 row_newbcast:10 row_mask:0xf bank_mask:0xf
    v_dot2c_f32_bf16_dpp v51, v20, v173 row_newbcast:10 row_mask:0xf bank_mask:0xf
    v_dot2c_f32_bf16_dpp v52, v20, v170 row_newbcast:10 row_mask:0xf bank_mask:0xf
    v_dot2c_f32_bf16_dpp v53, v20, v174 row_newbcast:10 row_mask:0xf bank_mask:0xf
    v_dot2c_f32_bf16_dpp v54, v20, v171 row_newbcast:10 row_mask:0xf bank_mask:0xf
    v_dot2c_f32_bf16_dpp v55, v20, v175 row_newbcast:10 row_mask:0xf bank_mask:0xf
    v_dot2c_f32_bf16_dpp v48, v20, v176 row_newbcast:12 row_mask:0xf bank_mask:0xf
    v_dot2c_f32_bf16_dpp v49, v20, v180 row_newbcast:12 row_mask:0xf bank_mask:0xf
    v_dot2c_f32_bf16_dpp v50, v20, v177 row_newbcast:12 row_mask:0xf bank_mask:0xf
    v_dot2c_f32_bf16_dpp v51, v20, v181 row_newbcast:12 row_mask:0xf bank_mask:0xf
    v_dot2c_f32_bf16_dpp v52, v20, v178 row_newbcast:12 row_mask:0xf bank_mask:0xf
    v_dot2c_f32_bf16_dpp v53, v20, v182 row_newbcast:12 row_mask:0xf bank_mask:0xf
    v_dot2c_f32_bf16_dpp v54, v20, v179 row_newbcast:12 row_mask:0xf bank_mask:0xf
    v_dot2c_f32_bf16_dpp v55, v20, v183 row_newbcast:12 row_mask:0xf bank_mask:0xf
    v_dot2c_f32_bf16_dpp v48, v20, v184 row_newbcast:14 row_mask:0xf bank_mask:0xf
    v_dot2c_f32_bf16_dpp v49, v20, v188 row_newbcast:14 row_mask:0xf bank_mask:0xf
    v_dot2c_f32_bf16_dpp v50, v20, v185 row_newbcast:14 row_mask:0xf bank_mask:0xf
    v_dot2c_f32_bf16_dpp v51, v20, v189 row_newbcast:14 row_mask:0xf bank_mask:0xf
    v_dot2c_f32_bf16_dpp v52, v20, v186 row_newbcast:14 row_mask:0xf bank_mask:0xf
    v_dot2c_f32_bf16_dpp v53, v20, v190 row_newbcast:14 row_mask:0xf bank_mask:0xf
    v_dot2c_f32_bf16_dpp v54, v20, v187 row_newbcast:14 row_mask:0xf bank_mask:0xf
    v_dot2c_f32_bf16_dpp v55, v20, v191 row_newbcast:14 row_mask:0xf bank_mask:0xf
    v_permlane32_swap_b32 v48, v52
    v_permlane32_swap_b32 v49, v53
    v_permlane32_swap_b32 v50, v54
    v_permlane32_swap_b32 v51, v55
    v_pk_add_f32 v[48:49], v[48:49], v[52:53]
    v_pk_add_f32 v[50:51], v[50:51], v[54:55]
    v_add_u32 v48, 0x200, v48
    v_and_or_b32 v48, v48, s14, v5
    v_add_u32 v49, 0x200, v49
    v_and_or_b32 v49, v49, s14, v5
    v_add_u32 v50, 0x200, v50
    v_and_or_b32 v50, v50, s14, v5
    v_add_u32 v51, 0x200, v51
    v_and_or_b32 v51, v51, s14, v5
    buffer_store_dwordx4 v[48:51], v15, s[72:75], s66 offen sc1
    s_nop 0
    s_branch L_end
L_final0:
    s_branch L_end
L_pollr_109:
    s_sleep 8
    s_sub_u32 s76, s76, 1
    s_cmp_eq_u32 s76, 0
    s_cbranch_scc1 L_end
    s_mov_b64 exec, s[100:101]
    s_branch L_poll_108
L_pollr_115:
    s_sleep 8
    s_sub_u32 s76, s76, 1
    s_cmp_eq_u32 s76, 0
    s_cbranch_scc1 L_end
    s_mov_b64 exec, s[100:101]
    s_branch L_poll_114
L_pollr_123:
    s_sub_u32 s76, s76, 1
    s_cmp_eq_u32 s76, 0
    s_cbranch_scc1 L_end
    s_mov_b64 exec, s[100:101]
    s_branch L_poll_122
L_pollr_127:
    s_sub_u32 s76, s76, 1
    s_cmp_eq_u32 s76, 0
    s_cbranch_scc1 L_end
    s_mov_b64 exec, s[100:101]
    s_branch L_poll_126
L_pollr_129:
    s_sub_u32 s76, s76, 1
    s_cmp_eq_u32 s76, 0
    s_cbranch_scc1 L_end
    s_mov_b64 exec, s[100:101]
    s_branch L_poll_128
L_pollr_131:
    s_sub_u32 s76, s76, 1
    s_cmp_eq_u32 s76, 0
    s_cbranch_scc1 L_end
    s_mov_b64 exec, s[100:101]
    s_branch L_poll_130
L_roleM:
    s_setprio 3
    s_lshl_b32 s96, s8, 5
    s_add_u32 s7, s7, s96
    s_mov_b32 s52, s22
    s_and_b32 s53, s23, 0xffff
    s_mov_b32 s54, 0x800000
    s_mov_b32 s55, 0x20000
    v_lshlrev_b32 v8, 5, v0
    buffer_load_dwordx4 v[128:131], v8, s[40:43], 0 offen
    buffer_load_dwordx4 v[132:135], v8, s[40:43], 0 offen offset:16
    v_lshrrev_b32 v9, 2, v0
    v_lshlrev_b32 v9, 4, v9
    s_lshl_b32 s96, s67, 8
    v_add_u32 v9, s96, v9
    v_lshlrev_b32 v10, 1, v9
    s_and_b32 s98, s7, 1
    s_mul_i32 s99, s98, 16
    s_sub_u32 s96, 16, s99
    buffer_load_dwordx4 v[136:139], v10, s[40:43], s99 offen
    buffer_load_dwordx4 v[140:143], v10, s[40:43], s96 offen
    v_lshlrev_b32 v10, 13, v9
    v_and_b32 v11, 3, v0
    v_lshl_add_u32 v10, v11, 4, v10
    s_lshl_b32 s97, s7, 6
    s_mul_i32 s98, s98, 65536
    s_sub_u32 s99, s97, s98
    s_add_u32 s97, s97, s98
    s_add_u32 s96, s97, 0
    buffer_load_dwordx4 v[64:67], v10, s[52:55], s96 offen
    s_add_u32 s96, s97, 8192
    buffer_load_dwordx4 v[68:71], v10, s[52:55], s96 offen
    s_add_u32 s96, s97, 16384
    buffer_load_dwordx4 v[72:75], v10, s[52:55], s96 offen
    s_add_u32 s96, s97, 24576
    buffer_load_dwordx4 v[76:79], v10, s[52:55], s96 offen
    s_add_u32 s96, s97, 32768
    buffer_load_dwordx4 v[80:83], v10, s[52:55], s96 offen
    s_add_u32 s96, s97, 40960
    buffer_load_dwordx4 v[84:87], v10, s[52:55], s96 offen
    s_add_u32 s96, s97, 49152
    buffer_load_dwordx4 v[88:91], v10, s[52:55], s96 offen
    s_add_u32 s96, s97, 57344
    buffer_load_dwordx4 v[92:95], v10, s[52:55], s96 offen
    s_add_u32 s96, s99, 65536
    buffer_load_dwordx4 v[96:99], v10, s[52:55], s96 offen
    s_add_u32 s96, s99, 73728
    buffer_load_dwordx4 v[100:103], v10, s[52:55], s96 offen
    s_add_u32 s96, s99, 81920
    buffer_load_dwordx4 v[104:107], v10, s[52:55], s96 offen
    s_add_u32 s96, s99, 90112
    buffer_load_dwordx4 v[108:111], v10, s[52:55], s96 offen
    s_add_u32 s96, s99, 98304
    buffer_load_dwordx4 v[112:115], v10, s[52:55], s96 offen
    s_add_u32 s96, s99, 106496
    buffer_load_dwordx4 v[116:119], v10, s[52:55], s96 offen
    s_add_u32 s96, s99, 114688
    buffer_load_dwordx4 v[120:123], v10, s[52:55], s96 offen
    s_add_u32 s96, s99, 122880
    buffer_load_dwordx4 v[124:127], v10, s[52:55], s96 offen
    s_barrier
    s_waitcnt vmcnt(16)
    v_lshlrev_b32 v144, 16, v128
    v_and_b32 v145, s15, v128
    v_lshlrev_b32 v146, 16, v129
    v_and_b32 v147, s15, v129
    v_lshlrev_b32 v148, 16, v130
    v_and_b32 v149, s15, v130
    v_lshlrev_b32 v150, 16, v131
    v_and_b32 v151, s15, v131
    v_lshlrev_b32 v152, 16, v132
    v_and_b32 v153, s15, v132
    v_lshlrev_b32 v154, 16, v133
    v_and_b32 v155, s15, v133
    v_lshlrev_b32 v156, 16, v134
    v_and_b32 v157, s15, v134
    v_lshlrev_b32 v158, 16, v135
    v_and_b32 v159, s15, v135
    v_add_f32 v162, v144, v145
    v_add_f32 v163, v146, v147
    v_add_f32 v162, v162, v148
    v_add_f32 v163, v163, v149
    v_add_f32 v162, v162, v150
    v_add_f32 v163, v163, v151
    v_add_f32 v162, v162, v152
    v_add_f32 v163, v163, v153
    v_add_f32 v162, v162, v154
    v_add_f32 v163, v163, v155
    v_add_f32 v162, v162, v156
    v_add_f32 v163, v163, v157
    v_add_f32 v162, v162, v158
    v_add_f32 v163, v163, v159
    v_add_f32 v162, v162, v163
    s_nop 1
    v_add_f32_dpp v162, v162, v162 row_ror:8 row_mask:0xf bank_mask:0xf
    s_nop 1
    v_add_f32_dpp v162, v162, v162 row_ror:4 row_mask:0xf bank_mask:0xf
    s_nop 1
    v_add_f32_dpp v162, v162, v162 row_ror:2 row_mask:0xf bank_mask:0xf
    s_nop 1
    v_add_f32_dpp v162, v162, v162 row_ror:1 row_mask:0xf bank_mask:0xf
    v_mov_b32 v163, v162
    s_nop 1
    v_permlane16_swap_b32 v163, v162
    v_add_f32 v162, v162, v163
    v_mov_b32 v163, v162
    s_nop 1
    v_permlane32_swap_b32 v163, v162
    v_add_f32 v162, v162, v163
    v_mul_f32 v162, 0x3a800000, v162
    v_sub_f32 v163, v144, v162
    v_mul_f32 v164, v163, v163
    v_sub_f32 v163, v145, v162
    v_fmac_f32 v164, v163, v163
    v_sub_f32 v163, v146, v162
    v_fmac_f32 v164, v163, v163
    v_sub_f32 v163, v147, v162
    v_fmac_f32 v164, v163, v163
    v_sub_f32 v163, v148, v162
    v_fmac_f32 v164, v163, v163
    v_sub_f32 v163, v149, v162
    v_fmac_f32 v164, v163, v163
    v_sub_f32 v163, v150, v162
    v_fmac_f32 v164, v163, v163
    v_sub_f32 v163, v151, v162
    v_fmac_f32 v164, v163, v163
    v_sub_f32 v163, v152, v162
    v_fmac_f32 v164, v163, v163
    v_sub_f32 v163, v153, v162
    v_fmac_f32 v164, v163, v163
    v_sub_f32 v163, v154, v162
    v_fmac_f32 v164, v163, v163
    v_sub_f32 v163, v155, v162
    v_fmac_f32 v164, v163, v163
    v_sub_f32 v163, v156, v162
    v_fmac_f32 v164, v163, v163
    v_sub_f32 v163, v157, v162
    v_fmac_f32 v164, v163, v163
    v_sub_f32 v163, v158, v162
    v_fmac_f32 v164, v163, v163
    v_sub_f32 v163, v159, v162
    v_fmac_f32 v164, v163, v163
    s_nop 1
    v_add_f32_dpp v164, v164, v164 row_ror:8 row_mask:0xf bank_mask:0xf
    s_nop 1
    v_add_f32_dpp v164, v164, v164 row_ror:4 row_mask:0xf bank_mask:0xf
    s_nop 1
    v_add_f32_dpp v164, v164, v164 row_ror:2 row_mask:0xf bank_mask:0xf
    s_nop 1
    v_add_f32_dpp v164, v164, v164 row_ror:1 row_mask:0xf bank_mask:0xf
    v_mov_b32 v163, v164
    s_nop 1
    v_permlane16_swap_b32 v163, v164
    v_add_f32 v164, v164, v163
    v_mov_b32 v163, v164
    s_nop 1
    v_permlane32_swap_b32 v163, v164
    v_add_f32 v164, v164, v163
    v_mul_f32 v164, 0x3a800000, v164
    v_cvt_pk_bf16_f32 v160, v162, v162
    v_and_b32 v160, s15, v160
    v_cvt_pk_bf16_f32 v164, v164, v164
    v_and_b32 v164, s15, v164
    v_add_f32 v164, 0x3727c5ac, v164
    v_cvt_pk_bf16_f32 v164, v164, v164
    v_and_b32 v164, s15, v164
    v_sqrt_f32 v164, v164
    s_nop 0
    v_cvt_pk_bf16_f32 v164, v164, v164
    v_and_b32 v164, s15, v164
    v_rcp_f32 v161, v164
    v_lshlrev_b32 v166, 16, v136
    v_and_b32 v167, s15, v136
    v_sub_f32 v166, v166, v160
    v_sub_f32 v167, v167, v160
    v_cvt_pk_bf16_f32 v167, v166, v167
    v_lshlrev_b32 v166, 16, v167
    v_and_b32 v167, s15, v167
    v_mul_f32 v166, v166, v161
    v_mul_f32 v167, v167, v161
    v_cvt_pk_bf16_f32 v168, v166, v167
    v_lshlrev_b32 v166, 16, v137
    v_and_b32 v167, s15, v137
    v_sub_f32 v166, v166, v160
    v_sub_f32 v167, v167, v160
    v_cvt_pk_bf16_f32 v167, v166, v167
    v_lshlrev_b32 v166, 16, v167
    v_and_b32 v167, s15, v167
    v_mul_f32 v166, v166, v161
    v_mul_f32 v167, v167, v161
    v_cvt_pk_bf16_f32 v169, v166, v167
    v_lshlrev_b32 v166, 16, v138
    v_and_b32 v167, s15, v138
    v_sub_f32 v166, v166, v160
    v_sub_f32 v167, v167, v160
    v_cvt_pk_bf16_f32 v167, v166, v167
    v_lshlrev_b32 v166, 16, v167
    v_and_b32 v167, s15, v167
    v_mul_f32 v166, v166, v161
    v_mul_f32 v167, v167, v161
    v_cvt_pk_bf16_f32 v170, v166, v167
    v_lshlrev_b32 v166, 16, v139
    v_and_b32 v167, s15, v139
    v_sub_f32 v166, v166, v160
    v_sub_f32 v167, v167, v160
    v_cvt_pk_bf16_f32 v167, v166, v167
    v_lshlrev_b32 v166, 16, v167
    v_and_b32 v167, s15, v167
    v_mul_f32 v166, v166, v161
    v_mul_f32 v167, v167, v161
    v_cvt_pk_bf16_f32 v171, v166, v167
    v_lshlrev_b32 v166, 16, v140
    v_and_b32 v167, s15, v140
    v_sub_f32 v166, v166, v160
    v_sub_f32 v167, v167, v160
    v_cvt_pk_bf16_f32 v167, v166, v167
    v_lshlrev_b32 v166, 16, v167
    v_and_b32 v167, s15, v167
    v_mul_f32 v166, v166, v161
    v_mul_f32 v167, v167, v161
    v_cvt_pk_bf16_f32 v172, v166, v167
    v_lshlrev_b32 v166, 16, v141
    v_and_b32 v167, s15, v141
    v_sub_f32 v166, v166, v160
    v_sub_f32 v167, v167, v160
    v_cvt_pk_bf16_f32 v167, v166, v167
    v_lshlrev_b32 v166, 16, v167
    v_and_b32 v167, s15, v167
    v_mul_f32 v166, v166, v161
    v_mul_f32 v167, v167, v161
    v_cvt_pk_bf16_f32 v173, v166, v167
    v_lshlrev_b32 v166, 16, v142
    v_and_b32 v167, s15, v142
    v_sub_f32 v166, v166, v160
    v_sub_f32 v167, v167, v160
    v_cvt_pk_bf16_f32 v167, v166, v167
    v_lshlrev_b32 v166, 16, v167
    v_and_b32 v167, s15, v167
    v_mul_f32 v166, v166, v161
    v_mul_f32 v167, v167, v161
    v_cvt_pk_bf16_f32 v174, v166, v167
    v_lshlrev_b32 v166, 16, v143
    v_and_b32 v167, s15, v143
    v_sub_f32 v166, v166, v160
    v_sub_f32 v167, v167, v160
    v_cvt_pk_bf16_f32 v167, v166, v167
    v_lshlrev_b32 v166, 16, v167
    v_and_b32 v167, s15, v167
    v_mul_f32 v166, v166, v161
    v_mul_f32 v167, v167, v161
    v_cvt_pk_bf16_f32 v175, v166, v167
    s_waitcnt vmcnt(14)
    v_perm_b32 v24, v68, v64, s12
    v_perm_b32 v25, v68, v64, s13
    v_perm_b32 v26, v69, v65, s12
    v_perm_b32 v27, v69, v65, s13
    v_perm_b32 v28, v70, v66, s12
    v_perm_b32 v29, v70, v66, s13
    v_perm_b32 v30, v71, v67, s12
    v_perm_b32 v31, v71, v67, s13
    v_dot2_f32_bf16 v16, v24, v168, 0
    v_dot2_f32_bf16 v17, v25, v168, 0
    v_dot2_f32_bf16 v18, v26, v168, 0
    v_dot2_f32_bf16 v19, v27, v168, 0
    v_dot2_f32_bf16 v20, v28, v168, 0
    v_dot2_f32_bf16 v21, v29, v168, 0
    v_dot2_f32_bf16 v22, v30, v168, 0
    v_dot2_f32_bf16 v23, v31, v168, 0
    s_waitcnt vmcnt(12)
    v_perm_b32 v24, v76, v72, s12
    v_perm_b32 v25, v76, v72, s13
    v_perm_b32 v26, v77, v73, s12
    v_perm_b32 v27, v77, v73, s13
    v_perm_b32 v28, v78, v74, s12
    v_perm_b32 v29, v78, v74, s13
    v_perm_b32 v30, v79, v75, s12
    v_perm_b32 v31, v79, v75, s13
    v_dot2_f32_bf16 v16, v24, v169, v16
    v_dot2_f32_bf16 v17, v25, v169, v17
    v_dot2_f32_bf16 v18, v26, v169, v18
    v_dot2_f32_bf16 v19, v27, v169, v19
    v_dot2_f32_bf16 v20, v28, v169, v20
    v_dot2_f32_bf16 v21, v29, v169, v21
    v_dot2_f32_bf16 v22, v30, v169, v22
    v_dot2_f32_bf16 v23, v31, v169, v23
    s_waitcnt vmcnt(10)
    v_perm_b32 v24, v84, v80, s12
    v_perm_b32 v25, v84, v80, s13
    v_perm_b32 v26, v85, v81, s12
    v_perm_b32 v27, v85, v81, s13
    v_perm_b32 v28, v86, v82, s12
    v_perm_b32 v29, v86, v82, s13
    v_perm_b32 v30, v87, v83, s12
    v_perm_b32 v31, v87, v83, s13
    v_dot2_f32_bf16 v16, v24, v170, v16
    v_dot2_f32_bf16 v17, v25, v170, v17
    v_dot2_f32_bf16 v18, v26, v170, v18
    v_dot2_f32_bf16 v19, v27, v170, v19
    v_dot2_f32_bf16 v20, v28, v170, v20
    v_dot2_f32_bf16 v21, v29, v170, v21
    v_dot2_f32_bf16 v22, v30, v170, v22
    v_dot2_f32_bf16 v23, v31, v170, v23
    s_waitcnt vmcnt(8)
    v_perm_b32 v24, v92, v88, s12
    v_perm_b32 v25, v92, v88, s13
    v_perm_b32 v26, v93, v89, s12
    v_perm_b32 v27, v93, v89, s13
    v_perm_b32 v28, v94, v90, s12
    v_perm_b32 v29, v94, v90, s13
    v_perm_b32 v30, v95, v91, s12
    v_perm_b32 v31, v95, v91, s13
    v_dot2_f32_bf16 v16, v24, v171, v16
    v_dot2_f32_bf16 v17, v25, v171, v17
    v_dot2_f32_bf16 v18, v26, v171, v18
    v_dot2_f32_bf16 v19, v27, v171, v19
    v_dot2_f32_bf16 v20, v28, v171, v20
    v_dot2_f32_bf16 v21, v29, v171, v21
    v_dot2_f32_bf16 v22, v30, v171, v22
    v_dot2_f32_bf16 v23, v31, v171, v23
    s_waitcnt vmcnt(6)
    v_perm_b32 v24, v100, v96, s12
    v_perm_b32 v25, v100, v96, s13
    v_perm_b32 v26, v101, v97, s12
    v_perm_b32 v27, v101, v97, s13
    v_perm_b32 v28, v102, v98, s12
    v_perm_b32 v29, v102, v98, s13
    v_perm_b32 v30, v103, v99, s12
    v_perm_b32 v31, v103, v99, s13
    v_dot2_f32_bf16 v16, v24, v172, v16
    v_dot2_f32_bf16 v17, v25, v172, v17
    v_dot2_f32_bf16 v18, v26, v172, v18
    v_dot2_f32_bf16 v19, v27, v172, v19
    v_dot2_f32_bf16 v20, v28, v172, v20
    v_dot2_f32_bf16 v21, v29, v172, v21
    v_dot2_f32_bf16 v22, v30, v172, v22
    v_dot2_f32_bf16 v23, v31, v172, v23
    s_waitcnt vmcnt(4)
    v_perm_b32 v24, v108, v104, s12
    v_perm_b32 v25, v108, v104, s13
    v_perm_b32 v26, v109, v105, s12
    v_perm_b32 v27, v109, v105, s13
    v_perm_b32 v28, v110, v106, s12
    v_perm_b32 v29, v110, v106, s13
    v_perm_b32 v30, v111, v107, s12
    v_perm_b32 v31, v111, v107, s13
    v_dot2_f32_bf16 v16, v24, v173, v16
    v_dot2_f32_bf16 v17, v25, v173, v17
    v_dot2_f32_bf16 v18, v26, v173, v18
    v_dot2_f32_bf16 v19, v27, v173, v19
    v_dot2_f32_bf16 v20, v28, v173, v20
    v_dot2_f32_bf16 v21, v29, v173, v21
    v_dot2_f32_bf16 v22, v30, v173, v22
    v_dot2_f32_bf16 v23, v31, v173, v23
    s_waitcnt vmcnt(2)
    v_perm_b32 v24, v116, v112, s12
    v_perm_b32 v25, v116, v112, s13
    v_perm_b32 v26, v117, v113, s12
    v_perm_b32 v27, v117, v113, s13
    v_perm_b32 v28, v118, v114, s12
    v_perm_b32 v29, v118, v114, s13
    v_perm_b32 v30, v119, v115, s12
    v_perm_b32 v31, v119, v115, s13
    v_dot2_f32_bf16 v16, v24, v174, v16
    v_dot2_f32_bf16 v17, v25, v174, v17
    v_dot2_f32_bf16 v18, v26, v174, v18
    v_dot2_f32_bf16 v19, v27, v174, v19
    v_dot2_f32_bf16 v20, v28, v174, v20
    v_dot2_f32_bf16 v21, v29, v174, v21
    v_dot2_f32_bf16 v22, v30, v174, v22
    v_dot2_f32_bf16 v23, v31, v174, v23
    s_waitcnt vmcnt(0)
    v_perm_b32 v24, v124, v120, s12
    v_perm_b32 v25, v124, v120, s13
    v_perm_b32 v26, v125, v121, s12
    v_perm_b32 v27, v125, v121, s13
    v_perm_b32 v28, v126, v122, s12
    v_perm_b32 v29, v126, v122, s13
    v_perm_b32 v30, v127, v123, s12
    v_perm_b32 v31, v127, v123, s13
    v_dot2_f32_bf16 v16, v24, v175, v16
    v_dot2_f32_bf16 v17, v25, v175, v17
    v_dot2_f32_bf16 v18, v26, v175, v18
    v_dot2_f32_bf16 v19, v27, v175, v19
    v_dot2_f32_bf16 v20, v28, v175, v20
    v_dot2_f32_bf16 v21, v29, v175, v21
    v_dot2_f32_bf16 v22, v30, v175, v22
    v_dot2_f32_bf16 v23, v31, v175, v23
    v_permlane32_swap_b32 v16, v20
    v_permlane32_swap_b32 v17, v21
    v_permlane32_swap_b32 v18, v22
    v_permlane32_swap_b32 v19, v23
    v_add_f32 v16, v16, v20
    v_add_f32 v17, v17, v21
    v_add_f32 v18, v18, v22
    v_add_f32 v19, v19, v23
    s_nop 0
    v_permlane16_swap_b32 v16, v18
    v_permlane16_swap_b32 v17, v19
    v_add_f32 v16, v16, v18
    v_add_f32 v17, v17, v19
    s_nop 0
    v_add_f32_dpp v16, v16, v16 row_ror:8 row_mask:0xf bank_mask:0xf
    v_add_f32_dpp v17, v17, v17 row_ror:8 row_mask:0xf bank_mask:0xf
    s_nop 0
    v_add_f32_dpp v16, v16, v16 row_ror:4 row_mask:0xf bank_mask:0xf
    v_add_f32_dpp v17, v17, v17 row_ror:4 row_mask:0xf bank_mask:0xf
    v_and_b32 v11, 3, v0
    v_lshlrev_b32 v11, 5, v11
    v_lshl_add_u32 v11, v2, 3, v11
    s_lshl_b32 s96, s67, 7
    v_add_u32 v11, s96, v11
    ds_write_b64 v11, v[16:17] offset:11264
    s_waitcnt lgkmcnt(0)
    s_add_u32 s78, s78, 1
    s_and_b32 s10, s78, 0xffff
    s_and_b32 s11, s78, 0x3ff
    v_mov_b32 v5, s11
    v_mov_b32 v9, 1
    s_mov_b64 exec, 1
    ds_add_rtn_u32 v8, v7, v9 offset:0
    s_waitcnt lgkmcnt(0)
    v_readfirstlane_b32 s96, v8
    s_mov_b64 exec, -1
    s_cmp_lg_u32 s96, 3
    s_nop 1
    s_cbranch_scc1 L_qpub_done
    s_mov_b64 exec, 0xff
    ds_read_b128 v[16:19], v4 offset:11264
    ds_read_b128 v[20:23], v4 offset:11392
    ds_read_b128 v[24:27], v4 offset:11520
    ds_read_b128 v[28:31], v4 offset:11648
    s_waitcnt lgkmcnt(0)
    v_add_f32 v16, v16, v24
    v_add_f32 v17, v17, v25
    v_add_f32 v18, v18, v26
    v_add_f32 v19, v19, v27
    v_add_f32 v20, v20, v28
    v_add_f32 v21, v21, v29
    v_add_f32 v22, v22, v30
    v_add_f32 v23, v23, v31
    v_add_f32 v16, v16, v20
    v_add_f32 v17, v17, v21
    v_add_f32 v18, v18, v22
    v_add_f32 v19, v19, v23
    v_cvt_pk_bf16_f32 v16, v16, v16
    v_and_b32 v16, s15, v16
    v_or_b32 v16, s10, v16
    v_cvt_pk_bf16_f32 v17, v17, v17
    v_and_b32 v17, s15, v17
    v_or_b32 v17, s10, v17
    v_cvt_pk_bf16_f32 v18, v18, v18
    v_and_b32 v18, s15, v18
    v_or_b32 v18, s10, v18
    v_cvt_pk_bf16_f32 v19, v19, v19
    v_and_b32 v19, s15, v19
    v_or_b32 v19, s10, v19
    s_lshl_b32 s96, s7, 7
    s_add_u32 s96, s96, 4096
    buffer_store_dwordx4 v[16:19], v4, s[72:75], s96 offen sc1
    s_mov_b64 exec, -1
    s_nop 0
L_qpub_done:
    s_setprio 0
    s_mul_i32 s7, s4, 14
    s_add_u32 s7, s7, s5
    s_sub_u32 s7, s7, 16
    s_cmp_lt_u32 s67, 2
    s_cselect_b32 s52, s28, s30
    s_cselect_b32 s53, s29, s31
    s_and_b32 s53, s53, 0xffff
    s_mov_b32 s54, 0x700000
    s_mov_b32 s55, 0x20000
    v_and_b32 v15, 31, v0
    v_lshlrev_b32 v60, 2, v15
    v_lshlrev_b32 v15, 5, v15
    v_lshrrev_b32 v8, 5, v0
    v_lshl_add_u32 v15, v8, 4, v15
    v_lshrrev_b32 v3, 3, v0
    v_lshlrev_b32 v3, 12, v3
    v_and_b32 v9, 7, v0
    v_lshl_add_u32 v3, v9, 4, v3
    v_lshlrev_b32 v57, 4, v9
    v_lshl_add_u32 v57, v2, 2, v57
    s_lshl_b32 s96, s67, 7
    v_add_u32 v57, s96, v57
    s_sub_u32 s16, s5, 16
    v_lshrrev_b32 v6, 5, v0
    v_mul_u32_u24 v6, 229376, v6
    v_lshl_add_u32 v6, v60, 2, v6
    s_mul_i32 s77, s16, 458752
    s_mul_i32 s98, s4, 896
    s_add_u32 s77, s77, s98
    s_and_b32 s99, s67, 1
    s_lshl_b32 s98, s99, 9
    s_add_u32 s77, s77, s98
    s_cmp_eq_u32 s99, 0
    s_cselect_b32 s18, -1, 0x00ffffff
    s_mov_b32 s19, s18
    v_mov_b32 v200, 0
    v_mov_b32 v201, 0
    v_mov_b32 v202, 0
    v_mov_b32 v203, 0
    v_mov_b32 v204, 0
    v_mov_b32 v205, 0
    v_mov_b32 v206, 0
    v_mov_b32 v207, 0
    v_mov_b32 v208, 0x3f803f80
    s_lshl_b32 s66, s4, 4
    s_add_u32 s66, s66, s16
    s_mul_i32 s66, s66, 3584
    s_lshr_b32 s97, s67, 1
    s_mul_i32 s97, s97, 1792
    s_add_u32 s66, s66, s97
    s_lshl_b32 s97, s99, 10
    s_add_u32 s66, s66, s97
    s_add_u32 s66, s66, 5242880
    v_and_b32 v61, 7, v0
    v_lshlrev_b32 v61, 4, v61
    v_lshrrev_b32 v8, 5, v0
    v_lshl_add_u32 v61, v8, 7, v61
    v_bfe_u32 v9, v0, 3, 2
    v_lshl_add_u32 v56, v9, 8, v61
    s_lshl_b32 s97, s4, 15
    s_lshl_b32 s98, s16, 11
    s_add_u32 s97, s97, s98
    v_add_u32 v56, s97, v56
    v_lshrrev_b32 v10, 1, v61
    s_lshl_b32 s96, s16, 7
    buffer_load_dwordx2 v[216:217], v10, s[40:43], s96 offen
    s_lshl_b32 s17, s4, 12
    s_lshl_b32 s98, s16, 8
    s_add_u32 s17, s17, s98
    s_add_u32 s17, s17, 65536
    s_lshl_b32 s96, s16, 1
    s_sub_u32 s96, s4, s96
    s_and_b32 s22, s96, 7
    s_lshl_b32 s65, s16, 1
    s_add_u32 s65, s65, s22
    s_and_b32 s65, s65, 31
    s_lshl_b32 s96, s67, 17
    s_lshl_b32 s97, s65, 7
    s_add_u32 s96, s96, s97
    v_add_u32 v44, s96, v3
    v_and_b32 v47, 7, v0
    v_lshlrev_b32 v46, 3, v47
    v_lshlrev_b32 v47, 4, v47
    s_waitcnt vmcnt(0)
    v_lshlrev_b32 v212, 16, v216
    v_and_b32 v213, s15, v216
    v_lshlrev_b32 v214, 16, v217
    v_and_b32 v215, s15, v217
    v_mov_b32 v48, 0
    v_mov_b32 v49, 0
    v_mov_b32 v50, 0
    v_mov_b32 v51, 0
    v_mov_b32 v52, 0
    v_mov_b32 v53, 0
    v_mov_b32 v54, 0
    v_mov_b32 v55, 0
    s_cmp_lg_u32 s67, 0
    s_cbranch_scc1 L_svc_M
L_ldsw_132:
    ds_read_b32 v8, v7 offset:32
    s_waitcnt lgkmcnt(0)
    v_readfirstlane_b32 s96, v8
    s_nop 0
    s_cmp_ge_u32 s96, 1
    s_nop 1
    s_cbranch_scc1 L_ldsd_133
    s_sleep 8
    s_sub_u32 s76, s76, 1
    s_cmp_lg_u32 s76, 0
    s_cbranch_scc1 L_ldsw_132
    s_branch L_end
L_ldsd_133:
    s_lshl_b32 s97, s8, 12
    v_add_u32 v12, s97, v4
    s_nop 1
L_poll_134:
    s_mov_b32 s96, 0x1000
    buffer_load_dwordx4 v[16:19], v12, s[72:75], s96 offen sc1
    s_mov_b32 s96, 0x1400
    buffer_load_dwordx4 v[20:23], v12, s[72:75], s96 offen sc1
    s_mov_b32 s96, 0x1800
    buffer_load_dwordx4 v[24:27], v12, s[72:75], s96 offen sc1
    s_mov_b32 s96, 0x1c00
    buffer_load_dwordx4 v[28:31], v12, s[72:75], s96 offen sc1
    s_waitcnt vmcnt(0)
    v_xor_b32 v16, s10, v16
    v_xor_b32 v17, s10, v17
    v_xor_b32 v18, s10, v18
    v_xor_b32 v19, s10, v19
    v_xor_b32 v20, s10, v20
    v_xor_b32 v21, s10, v21
    v_xor_b32 v22, s10, v22
    v_xor_b32 v23, s10, v23
    v_xor_b32 v24, s10, v24
    v_xor_b32 v25, s10, v25
    v_xor_b32 v26, s10, v26
    v_xor_b32 v27, s10, v27
    v_xor_b32 v28, s10, v28
    v_xor_b32 v29, s10, v29
    v_xor_b32 v30, s10, v30
    v_xor_b32 v31, s10, v31
    v_or3_b32 v32, v16, v17, v18
    v_or3_b32 v33, v19, v20, v21
    v_or3_b32 v34, v22, v23, v24
    v_or3_b32 v35, v25, v26, v27
    v_or3_b32 v36, v28, v29, v30
    v_or3_b32 v32, v32, v33, v34
    v_or3_b32 v35, v35, v36, v31
    v_or_b32 v32, v32, v35
    v_and_b32 v32, 0xffff, v32
    v_cmp_ne_u32 s[100:101], 0, v32
    s_mov_b64 exec, -1
    s_cmp_lg_u64 s[100:101], 0
    s_nop 1
    s_cbranch_scc1 L_pollr_135
    v_lshrrev_b32 v9, 5, v0
    v_mul_u32_u24 v9, 272, v9
    v_and_b32 v10, 31, v0
    v_lshl_add_u32 v9, v10, 3, v9
    v_perm_b32 v32, v17, v16, s13
    v_perm_b32 v33, v19, v18, s13
    ds_write_b64 v9, v[32:33] offset:512
    v_perm_b32 v34, v21, v20, s13
    v_perm_b32 v35, v23, v22, s13
    ds_write_b64 v9, v[34:35] offset:1056
    v_perm_b32 v36, v25, v24, s13
    v_perm_b32 v37, v27, v26, s13
    ds_write_b64 v9, v[36:37] offset:1600
    v_perm_b32 v38, v29, v28, s13
    v_perm_b32 v39, v31, v30, s13
    ds_write_b64 v9, v[38:39] offset:2144
    v_mov_b32 v9, 1
    ds_write_b32 v7, v9 offset:4
    s_nop 0
L_ldsw_136:
    ds_read_b32 v8, v7 offset:8
    s_waitcnt lgkmcnt(0)
    v_readfirstlane_b32 s96, v8
    s_nop 0
    s_cmp_ge_u32 s96, 4
    s_nop 1
    s_cbranch_scc1 L_ldsd_137
    s_sleep 4
    s_sub_u32 s76, s76, 1
    s_cmp_lg_u32 s76, 0
    s_cbranch_scc1 L_ldsw_136
    s_branch L_end
L_ldsd_137:
    v_and_b32 v8, 7, v0
    v_lshlrev_b32 v8, 3, v8
    v_lshrrev_b32 v9, 3, v0
    v_lshl_add_u32 v8, v9, 7, v8
    ds_read_b64 v[16:17], v8 offset:3072
    ds_read_b64 v[18:19], v8 offset:3136
    s_waitcnt lgkmcnt(0)
    v_max_f32 v10, v16, v18
    s_nop 1
    v_max_f32_dpp v10, v10, v10 row_ror:8 row_mask:0xf bank_mask:0xf
    v_mov_b32 v22, v10
    s_nop 1
    v_permlane16_swap_b32 v22, v10
    v_max_f32 v10, v10, v22
    v_mov_b32 v22, v10
    s_nop 1
    v_permlane32_swap_b32 v22, v10
    v_max_f32 v10, v10, v22
    v_sub_f32 v16, v16, v10
    v_mul_f32 v16, s79, v16
    v_exp_f32 v16, v16
    v_sub_f32 v18, v18, v10
    v_mul_f32 v18, s79, v18
    v_exp_f32 v18, v18
    v_mul_f32 v11, v16, v17
    v_fmac_f32 v11, v18, v19
    s_nop 1
    v_add_f32_dpp v11, v11, v11 row_ror:8 row_mask:0xf bank_mask:0xf
    v_mov_b32 v22, v11
    s_nop 1
    v_permlane16_swap_b32 v22, v11
    v_add_f32 v11, v11, v22
    v_mov_b32 v22, v11
    s_nop 1
    v_permlane32_swap_b32 v22, v11
    v_add_f32 v11, v11, v22
    v_or_b32 v10, s11, v10
    v_add_u32 v11, 0x200, v11
    v_and_or_b32 v11, v11, s14, v5
    s_getreg_b32 s97, hwreg(HW_REG_XCC_ID, 0, 4)
    s_lshl_b32 s97, s97, 16
    s_or_b32 s23, s97, s11
    s_mov_b64 exec, 0xff00
    v_mov_b32 v10, s23
    v_mov_b32 v11, s23
    s_mov_b64 exec, -1
    v_lshlrev_b32 v8, 3, v0
    s_lshl_b32 s96, s6, 7
    s_add_u32 s96, s96, 32768
    s_mov_b64 exec, 0xffff
    buffer_store_dwordx2 v[10:11], v8, s[72:75], s96 offen sc1
    s_mov_b64 exec, -1
L_ldsw_138:
    ds_read_b32 v8, v7 offset:36
    s_waitcnt lgkmcnt(0)
    v_readfirstlane_b32 s96, v8
    s_nop 0
    s_cmp_ge_u32 s96, 1
    s_nop 1
    s_cbranch_scc1 L_ldsd_139
    s_sleep 8
    s_sub_u32 s76, s76, 1
    s_cmp_lg_u32 s76, 0
    s_cbranch_scc1 L_ldsw_138
    s_branch L_end
L_ldsd_139:
    v_lshrrev_b32 v12, 2, v0
    v_lshlrev_b32 v12, 7, v12
    v_and_b32 v13, 3, v0
    v_lshl_add_u32 v12, v13, 4, v12
    s_lshl_b32 s97, s8, 13
    v_add_u32 v12, s97, v12
    v_and_b32 v13, 31, v0
    v_lshlrev_b32 v13, 7, v13
    s_lshl_b32 s97, s4, 12
    v_add_u32 v13, s97, v13
    s_nop 1
L_poll_140:
    s_mov_b32 s96, 0x8000
    buffer_load_dwordx4 v[16:19], v12, s[72:75], s96 offen sc1
    s_mov_b32 s96, 0x8800
    buffer_load_dwordx4 v[20:23], v12, s[72:75], s96 offen sc1
    s_mov_b32 s96, 0x9000
    buffer_load_dwordx4 v[24:27], v12, s[72:75], s96 offen sc1
    s_mov_b32 s96, 0x9800
    buffer_load_dwordx4 v[28:31], v12, s[72:75], s96 offen sc1
    s_mov_b32 s96, 0x8040
    buffer_load_dwordx4 v[32:35], v13, s[72:75], s96 offen sc1
    s_waitcnt vmcnt(0)
    v_xor_b32 v16, s11, v16
    v_xor_b32 v17, s11, v17
    v_xor_b32 v18, s11, v18
    v_xor_b32 v19, s11, v19
    v_xor_b32 v20, s11, v20
    v_xor_b32 v21, s11, v21
    v_xor_b32 v22, s11, v22
    v_xor_b32 v23, s11, v23
    v_xor_b32 v24, s11, v24
    v_xor_b32 v25, s11, v25
    v_xor_b32 v26, s11, v26
    v_xor_b32 v27, s11, v27
    v_xor_b32 v28, s11, v28
    v_xor_b32 v29, s11, v29
    v_xor_b32 v30, s11, v30
    v_xor_b32 v31, s11, v31
    v_xor_b32 v32, s11, v32
    v_xor_b32 v33, s11, v33
    v_xor_b32 v34, s11, v34
    v_xor_b32 v35, s11, v35
    v_or3_b32 v236, v16, v17, v18
    v_or3_b32 v237, v19, v20, v21
    v_or3_b32 v238, v22, v23, v24
    v_or3_b32 v239, v25, v26, v27
    v_or3_b32 v240, v28, v29, v30
    v_or3_b32 v241, v31, v32, v33
    v_or_b32 v242, v34, v35
    v_or3_b32 v236, v236, v237, v238
    v_or3_b32 v239, v239, v240, v241
    v_or3_b32 v236, v236, v239, v242
    v_and_b32 v236, 0x3ff, v236
    v_cmp_ne_u32 s[100:101], 0, v236
    s_mov_b64 exec, -1
    s_cmp_lg_u64 s[100:101], 0
    s_nop 1
    s_cbranch_scc1 L_pollr_141
    s_andn2_b32 s97, s23, 0x3ff
    v_cmp_ne_u32 s[100:101], s97, v32
    s_nop 0
    s_cmp_eq_u64 s[100:101], 0
    s_cselect_b32 s97, 1, 0
    v_mov_b32 v32, s97
    ds_write_b32 v7, v32 offset:52
    v_max_f32 v236, v16, v20
    v_max3_f32 v236, v236, v24, v28
    v_max_f32 v238, v18, v22
    v_max3_f32 v238, v238, v26, v30
    v_max_f32_dpp v236, v236, v236 row_ror:8 row_mask:0xf bank_mask:0xf
    s_nop 1
    v_max_f32_dpp v236, v236, v236 row_ror:4 row_mask:0xf bank_mask:0xf
    v_mov_b32 v240, v236
    s_nop 1
    v_permlane16_swap_b32 v240, v236
    v_max_f32 v236, v236, v240
    v_mov_b32 v240, v236
    s_nop 1
    v_permlane32_swap_b32 v240, v236
    v_max_f32 v236, v236, v240
    v_max_f32_dpp v238, v238, v238 row_ror:8 row_mask:0xf bank_mask:0xf
    s_nop 1
    v_max_f32_dpp v238, v238, v238 row_ror:4 row_mask:0xf bank_mask:0xf
    v_mov_b32 v240, v238
    s_nop 1
    v_permlane16_swap_b32 v240, v238
    v_max_f32 v238, v238, v240
    v_mov_b32 v240, v238
    s_nop 1
    v_permlane32_swap_b32 v240, v238
    v_max_f32 v238, v238, v240
    v_sub_f32 v16, v16, v236
    v_mul_f32 v16, s79, v16
    v_exp_f32 v16, v16
    v_sub_f32 v20, v20, v236
    v_mul_f32 v20, s79, v20
    v_exp_f32 v20, v20
    v_sub_f32 v24, v24, v236
    v_mul_f32 v24, s79, v24
    v_exp_f32 v24, v24
    v_sub_f32 v28, v28, v236
    v_mul_f32 v28, s79, v28
    v_exp_f32 v28, v28
    v_mul_f32 v237, v16, v17
    v_fmac_f32 v237, v20, v21
    v_fmac_f32 v237, v24, v25
    v_fmac_f32 v237, v28, v29
    v_sub_f32 v18, v18, v238
    v_mul_f32 v18, s79, v18
    v_exp_f32 v18, v18
    v_sub_f32 v22, v22, v238
    v_mul_f32 v22, s79, v22
    v_exp_f32 v22, v22
    v_sub_f32 v26, v26, v238
    v_mul_f32 v26, s79, v26
    v_exp_f32 v26, v26
    v_sub_f32 v30, v30, v238
    v_mul_f32 v30, s79, v30
    v_exp_f32 v30, v30
    v_mul_f32 v239, v18, v19
    v_fmac_f32 v239, v22, v23
    v_fmac_f32 v239, v26, v27
    v_fmac_f32 v239, v30, v31
    v_add_f32_dpp v237, v237, v237 row_ror:8 row_mask:0xf bank_mask:0xf
    s_nop 1
    v_add_f32_dpp v237, v237, v237 row_ror:4 row_mask:0xf bank_mask:0xf
    v_mov_b32 v240, v237
    s_nop 1
    v_permlane16_swap_b32 v240, v237
    v_add_f32 v237, v237, v240
    v_mov_b32 v240, v237
    s_nop 1
    v_permlane32_swap_b32 v240, v237
    v_add_f32 v237, v237, v240
    v_rcp_f32 v237, v237
    v_add_f32_dpp v239, v239, v239 row_ror:8 row_mask:0xf bank_mask:0xf
    s_nop 1
    v_add_f32_dpp v239, v239, v239 row_ror:4 row_mask:0xf bank_mask:0xf
    v_mov_b32 v240, v239
    s_nop 1
    v_permlane16_swap_b32 v240, v239
    v_add_f32 v239, v239, v240
    v_mov_b32 v240, v239
    s_nop 1
    v_permlane32_swap_b32 v240, v239
    v_add_f32 v239, v239, v240
    v_rcp_f32 v239, v239
    v_and_b32 v8, 3, v0
    v_lshlrev_b32 v8, 4, v8
    ds_write_b128 v8, v[236:239] offset:5120
    v_and_b32 v8, 7, v0
    v_lshlrev_b32 v8, 3, v8
    v_bfe_u32 v10, v0, 3, 2
    v_lshl_add_u32 v10, v10, 8, v8
    ds_read_b64 v[16:17], v8 offset:5120
    ds_read_b32 v18, v10 offset:3072
    v_and_b32 v11, 31, v0
    v_lshlrev_b32 v11, 2, v11
    s_waitcnt lgkmcnt(0)
    v_sub_f32 v18, v18, v16
    v_mul_f32 v18, s79, v18
    v_exp_f32 v18, v18
    s_nop 0
    v_mul_f32 v18, v18, v17
    ds_write_b32 v11, v18 offset:5248
    v_mov_b32 v9, 1
    ds_write_b32 v7, v9 offset:12
    s_nop 0
L_svc_M:
L_ldsw_142:
    ds_read_b32 v8, v7 offset:12
    s_waitcnt lgkmcnt(0)
    v_readfirstlane_b32 s96, v8
    s_nop 0
    s_cmp_ge_u32 s96, 1
    s_nop 1
    s_cbranch_scc1 L_ldsd_143
    s_sleep 8
    s_sub_u32 s76, s76, 1
    s_cmp_lg_u32 s76, 0
    s_cbranch_scc1 L_ldsw_142
    s_branch L_end
L_ldsd_143:
    ds_read_b32 v8, v7 offset:52
    s_waitcnt lgkmcnt(0)
    v_readfirstlane_b32 s26, v8
    s_nop 4
L_ldsw_144:
    ds_read_b32 v8, v7 offset:20
    s_waitcnt lgkmcnt(0)
    v_readfirstlane_b32 s96, v8
    s_nop 0
    s_cmp_ge_u32 s96, 4
    s_nop 1
    s_cbranch_scc1 L_ldsd_145
    s_sleep 4
    s_sub_u32 s76, s76, 1
    s_cmp_lg_u32 s76, 0
    s_cbranch_scc1 L_ldsw_144
    s_branch L_end
L_ldsd_145:
    s_add_u32 s96, s77, 0
    s_mov_b64 exec, s[18:19]
    buffer_load_dwordx4 v[72:75], v6, s[52:55], s96 offen nt
    s_mov_b64 exec, -1
    s_add_u32 s96, s77, 7168
    s_mov_b64 exec, s[18:19]
    buffer_load_dwordx4 v[76:79], v6, s[52:55], s96 offen nt
    s_mov_b64 exec, -1
    s_add_u32 s96, s77, 14336
    s_mov_b64 exec, s[18:19]
    buffer_load_dwordx4 v[80:83], v6, s[52:55], s96 offen nt
    s_mov_b64 exec, -1
    s_add_u32 s96, s77, 21504
    s_mov_b64 exec, s[18:19]
    buffer_load_dwordx4 v[84:87], v6, s[52:55], s96 offen nt
    s_mov_b64 exec, -1
    s_add_u32 s96, s77, 28672
    s_mov_b64 exec, s[18:19]
    buffer_load_dwordx4 v[88:91], v6, s[52:55], s96 offen nt
    s_mov_b64 exec, -1
    s_add_u32 s96, s77, 35840
    s_mov_b64 exec, s[18:19]
    buffer_load_dwordx4 v[92:95], v6, s[52:55], s96 offen nt
    s_mov_b64 exec, -1
    s_add_u32 s96, s77, 43008
    s_mov_b64 exec, s[18:19]
    buffer_load_dwordx4 v[96:99], v6, s[52:55], s96 offen nt
    s_mov_b64 exec, -1
    s_add_u32 s96, s77, 50176
    s_mov_b64 exec, s[18:19]
    buffer_load_dwordx4 v[100:103], v6, s[52:55], s96 offen nt
    s_mov_b64 exec, -1
    s_add_u32 s96, s77, 57344
    s_mov_b64 exec, s[18:19]
    buffer_load_dwordx4 v[104:107], v6, s[52:55], s96 offen nt
    s_mov_b64 exec, -1
    s_add_u32 s96, s77, 64512
    s_mov_b64 exec, s[18:19]
    buffer_load_dwordx4 v[108:111], v6, s[52:55], s96 offen nt
    s_mov_b64 exec, -1
    s_add_u32 s96, s77, 71680
    s_mov_b64 exec, s[18:19]
    buffer_load_dwordx4 v[112:115], v6, s[52:55], s96 offen nt
    s_mov_b64 exec, -1
    s_add_u32 s96, s77, 78848
    s_mov_b64 exec, s[18:19]
    buffer_load_dwordx4 v[116:119], v6, s[52:55], s96 offen nt
    s_mov_b64 exec, -1
    s_add_u32 s96, s77, 86016
    s_waitcnt vmcnt(11)
    s_mov_b64 exec, s[18:19]
    buffer_load_dwordx4 v[120:123], v6, s[52:55], s96 offen nt
    s_mov_b64 exec, -1
    s_add_u32 s96, s77, 93184
    s_waitcnt vmcnt(11)
    s_mov_b64 exec, s[18:19]
    buffer_load_dwordx4 v[124:127], v6, s[52:55], s96 offen nt
    s_mov_b64 exec, -1
    v_perm_b32 v64, v76, v72, s12
    v_perm_b32 v68, v76, v72, s13
    v_perm_b32 v65, v77, v73, s12
    v_perm_b32 v69, v77, v73, s13
    v_perm_b32 v66, v78, v74, s12
    v_perm_b32 v70, v78, v74, s13
    v_perm_b32 v67, v79, v75, s12
    v_perm_b32 v71, v79, v75, s13
    v_dot2c_f32_bf16 v200, v208, v64
    v_dot2c_f32_bf16 v201, v208, v68
    v_dot2c_f32_bf16 v202, v208, v65
    v_dot2c_f32_bf16 v203, v208, v69
    v_dot2c_f32_bf16 v204, v208, v66
    v_dot2c_f32_bf16 v205, v208, v70
    v_dot2c_f32_bf16 v206, v208, v67
    v_dot2c_f32_bf16 v207, v208, v71
    s_add_u32 s96, s77, 100352
    s_waitcnt vmcnt(11)
    s_mov_b64 exec, s[18:19]
    buffer_load_dwordx4 v[128:131], v6, s[52:55], s96 offen nt
    s_mov_b64 exec, -1
    s_add_u32 s96, s77, 107520
    s_waitcnt vmcnt(11)
    s_mov_b64 exec, s[18:19]
    buffer_load_dwordx4 v[132:135], v6, s[52:55], s96 offen nt
    s_mov_b64 exec, -1
    v_perm_b32 v72, v84, v80, s12
    v_perm_b32 v76, v84, v80, s13
    v_perm_b32 v73, v85, v81, s12
    v_perm_b32 v77, v85, v81, s13
    v_perm_b32 v74, v86, v82, s12
    v_perm_b32 v78, v86, v82, s13
    v_perm_b32 v75, v87, v83, s12
    v_perm_b32 v79, v87, v83, s13
    v_dot2c_f32_bf16 v200, v208, v72
    v_dot2c_f32_bf16 v201, v208, v76
    v_dot2c_f32_bf16 v202, v208, v73
    v_dot2c_f32_bf16 v203, v208, v77
    v_dot2c_f32_bf16 v204, v208, v74
    v_dot2c_f32_bf16 v205, v208, v78
    v_dot2c_f32_bf16 v206, v208, v75
    v_dot2c_f32_bf16 v207, v208, v79
    s_add_u32 s96, s77, 114688
    s_waitcnt vmcnt(11)
    s_mov_b64 exec, s[18:19]
    buffer_load_dwordx4 v[136:139], v6, s[52:55], s96 offen nt
    s_mov_b64 exec, -1
    s_add_u32 s96, s77, 121856
    s_waitcnt vmcnt(11)
    s_mov_b64 exec, s[18:19]
    buffer_load_dwordx4 v[140:143], v6, s[52:55], s96 offen nt
    s_mov_b64 exec, -1
    v_perm_b32 v80, v92, v88, s12
    v_perm_b32 v84, v92, v88, s13
    v_perm_b32 v81, v93, v89, s12
    v_perm_b32 v85, v93, v89, s13
    v_perm_b32 v82, v94, v90, s12
    v_perm_b32 v86, v94, v90, s13
    v_perm_b32 v83, v95, v91, s12
    v_perm_b32 v87, v95, v91, s13
    v_dot2c_f32_bf16 v200, v208, v80
    v_dot2c_f32_bf16 v201, v208, v84
    v_dot2c_f32_bf16 v202, v208, v81
    v_dot2c_f32_bf16 v203, v208, v85
    v_dot2c_f32_bf16 v204, v208, v82
    v_dot2c_f32_bf16 v205, v208, v86
    v_dot2c_f32_bf16 v206, v208, v83
    v_dot2c_f32_bf16 v207, v208, v87
    s_add_u32 s96, s77, 129024
    s_waitcnt vmcnt(11)
    s_mov_b64 exec, s[18:19]
    buffer_load_dwordx4 v[144:147], v6, s[52:55], s96 offen nt
    s_mov_b64 exec, -1
    s_add_u32 s96, s77, 136192
    s_waitcnt vmcnt(11)
    s_mov_b64 exec, s[18:19]
    buffer_load_dwordx4 v[148:151], v6, s[52:55], s96 offen nt
    s_mov_b64 exec, -1
    v_perm_b32 v88, v100, v96, s12
    v_perm_b32 v92, v100, v96, s13
    v_perm_b32 v89, v101, v97, s12
    v_perm_b32 v93, v101, v97, s13
    v_perm_b32 v90, v102, v98, s12
    v_perm_b32 v94, v102, v98, s13
    v_perm_b32 v91, v103, v99, s12
    v_perm_b32 v95, v103, v99, s13
    v_dot2c_f32_bf16 v200, v208, v88
    v_dot2c_f32_bf16 v201, v208, v92
    v_dot2c_f32_bf16 v202, v208, v89
    v_dot2c_f32_bf16 v203, v208, v93
    v_dot2c_f32_bf16 v204, v208, v90
    v_dot2c_f32_bf16 v205, v208, v94
    v_dot2c_f32_bf16 v206, v208, v91
    v_dot2c_f32_bf16 v207, v208, v95
    s_add_u32 s96, s77, 143360
    s_waitcnt vmcnt(11)
    s_mov_b64 exec, s[18:19]
    buffer_load_dwordx4 v[152:155], v6, s[52:55], s96 offen nt
    s_mov_b64 exec, -1
    s_add_u32 s96, s77, 150528
    s_waitcnt vmcnt(11)
    s_mov_b64 exec, s[18:19]
    buffer_load_dwordx4 v[156:159], v6, s[52:55], s96 offen nt
    s_mov_b64 exec, -1
    v_perm_b32 v96, v108, v104, s12
    v_perm_b32 v100, v108, v104, s13
    v_perm_b32 v97, v109, v105, s12
    v_perm_b32 v101, v109, v105, s13
    v_perm_b32 v98, v110, v106, s12
    v_perm_b32 v102, v110, v106, s13
    v_perm_b32 v99, v111, v107, s12
    v_perm_b32 v103, v111, v107, s13
    v_dot2c_f32_bf16 v200, v208, v96
    v_dot2c_f32_bf16 v201, v208, v100
    v_dot2c_f32_bf16 v202, v208, v97
    v_dot2c_f32_bf16 v203, v208, v101
    v_dot2c_f32_bf16 v204, v208, v98
    v_dot2c_f32_bf16 v205, v208, v102
    v_dot2c_f32_bf16 v206, v208, v99
    v_dot2c_f32_bf16 v207, v208, v103
    s_add_u32 s96, s77, 157696
    s_waitcnt vmcnt(11)
    s_mov_b64 exec, s[18:19]
    buffer_load_dwordx4 v[160:163], v6, s[52:55], s96 offen nt
    s_mov_b64 exec, -1
    s_add_u32 s96, s77, 164864
    s_waitcnt vmcnt(11)
    s_mov_b64 exec, s[18:19]
    buffer_load_dwordx4 v[164:167], v6, s[52:55], s96 offen nt
    s_mov_b64 exec, -1
    v_perm_b32 v104, v116, v112, s12
    v_perm_b32 v108, v116, v112, s13
    v_perm_b32 v105, v117, v113, s12
    v_perm_b32 v109, v117, v113, s13
    v_perm_b32 v106, v118, v114, s12
    v_perm_b32 v110, v118, v114, s13
    v_perm_b32 v107, v119, v115, s12
    v_perm_b32 v111, v119, v115, s13
    v_dot2c_f32_bf16 v200, v208, v104
    v_dot2c_f32_bf16 v201, v208, v108
    v_dot2c_f32_bf16 v202, v208, v105
    v_dot2c_f32_bf16 v203, v208, v109
    v_dot2c_f32_bf16 v204, v208, v106
    v_dot2c_f32_bf16 v205, v208, v110
    v_dot2c_f32_bf16 v206, v208, v107
    v_dot2c_f32_bf16 v207, v208, v111
    s_add_u32 s96, s77, 172032
    s_waitcnt vmcnt(11)
    s_mov_b64 exec, s[18:19]
    buffer_load_dwordx4 v[168:171], v6, s[52:55], s96 offen nt
    s_mov_b64 exec, -1
    s_add_u32 s96, s77, 179200
    s_waitcnt vmcnt(11)
    s_mov_b64 exec, s[18:19]
    buffer_load_dwordx4 v[172:175], v6, s[52:55], s96 offen nt
    s_mov_b64 exec, -1
    v_perm_b32 v112, v124, v120, s12
    v_perm_b32 v116, v124, v120, s13
    v_perm_b32 v113, v125, v121, s12
    v_perm_b32 v117, v125, v121, s13
    v_perm_b32 v114, v126, v122, s12
    v_perm_b32 v118, v126, v122, s13
    v_perm_b32 v115, v127, v123, s12
    v_perm_b32 v119, v127, v123, s13
    v_dot2c_f32_bf16 v200, v208, v112
    v_dot2c_f32_bf16 v201, v208, v116
    v_dot2c_f32_bf16 v202, v208, v113
    v_dot2c_f32_bf16 v203, v208, v117
    v_dot2c_f32_bf16 v204, v208, v114
    v_dot2c_f32_bf16 v205, v208, v118
    v_dot2c_f32_bf16 v206, v208, v115
    v_dot2c_f32_bf16 v207, v208, v119
    s_add_u32 s96, s77, 186368
    s_waitcnt vmcnt(11)
    s_mov_b64 exec, s[18:19]
    buffer_load_dwordx4 v[176:179], v6, s[52:55], s96 offen nt
    s_mov_b64 exec, -1
    s_add_u32 s96, s77, 193536
    s_waitcnt vmcnt(11)
    s_mov_b64 exec, s[18:19]
    buffer_load_dwordx4 v[180:183], v6, s[52:55], s96 offen nt
    s_mov_b64 exec, -1
    v_perm_b32 v120, v132, v128, s12
    v_perm_b32 v124, v132, v128, s13
    v_perm_b32 v121, v133, v129, s12
    v_perm_b32 v125, v133, v129, s13
    v_perm_b32 v122, v134, v130, s12
    v_perm_b32 v126, v134, v130, s13
    v_perm_b32 v123, v135, v131, s12
    v_perm_b32 v127, v135, v131, s13
    v_dot2c_f32_bf16 v200, v208, v120
    v_dot2c_f32_bf16 v201, v208, v124
    v_dot2c_f32_bf16 v202, v208, v121
    v_dot2c_f32_bf16 v203, v208, v125
    v_dot2c_f32_bf16 v204, v208, v122
    v_dot2c_f32_bf16 v205, v208, v126
    v_dot2c_f32_bf16 v206, v208, v123
    v_dot2c_f32_bf16 v207, v208, v127
    s_add_u32 s96, s77, 200704
    s_waitcnt vmcnt(11)
    s_mov_b64 exec, s[18:19]
    buffer_load_dwordx4 v[184:187], v6, s[52:55], s96 offen nt
    s_mov_b64 exec, -1
    s_add_u32 s96, s77, 207872
    s_waitcnt vmcnt(11)
    s_mov_b64 exec, s[18:19]
    buffer_load_dwordx4 v[188:191], v6, s[52:55], s96 offen nt
    s_mov_b64 exec, -1
    v_perm_b32 v128, v140, v136, s12
    v_perm_b32 v132, v140, v136, s13
    v_perm_b32 v129, v141, v137, s12
    v_perm_b32 v133, v141, v137, s13
    v_perm_b32 v130, v142, v138, s12
    v_perm_b32 v134, v142, v138, s13
    v_perm_b32 v131, v143, v139, s12
    v_perm_b32 v135, v143, v139, s13
    v_dot2c_f32_bf16 v200, v208, v128
    v_dot2c_f32_bf16 v201, v208, v132
    v_dot2c_f32_bf16 v202, v208, v129
    v_dot2c_f32_bf16 v203, v208, v133
    v_dot2c_f32_bf16 v204, v208, v130
    v_dot2c_f32_bf16 v205, v208, v134
    v_dot2c_f32_bf16 v206, v208, v131
    v_dot2c_f32_bf16 v207, v208, v135
    s_add_u32 s96, s77, 215040
    s_waitcnt vmcnt(11)
    s_mov_b64 exec, s[18:19]
    buffer_load_dwordx4 v[192:195], v6, s[52:55], s96 offen nt
    s_mov_b64 exec, -1
    s_add_u32 s96, s77, 222208
    s_waitcnt vmcnt(11)
    s_mov_b64 exec, s[18:19]
    buffer_load_dwordx4 v[196:199], v6, s[52:55], s96 offen nt
    s_mov_b64 exec, -1
    v_perm_b32 v136, v148, v144, s12
    v_perm_b32 v140, v148, v144, s13
    v_perm_b32 v137, v149, v145, s12
    v_perm_b32 v141, v149, v145, s13
    v_perm_b32 v138, v150, v146, s12
    v_perm_b32 v142, v150, v146, s13
    v_perm_b32 v139, v151, v147, s12
    v_perm_b32 v143, v151, v147, s13
    v_dot2c_f32_bf16 v200, v208, v136
    v_dot2c_f32_bf16 v201, v208, v140
    v_dot2c_f32_bf16 v202, v208, v137
    v_dot2c_f32_bf16 v203, v208, v141
    v_dot2c_f32_bf16 v204, v208, v138
    v_dot2c_f32_bf16 v205, v208, v142
    v_dot2c_f32_bf16 v206, v208, v139
    v_dot2c_f32_bf16 v207, v208, v143
    s_add_u32 s77, s66, 0
    s_add_u32 s20, s66, 524288
    s_add_u32 s21, s77, 524288
    s_mov_b32 s96, 0x380000
    buffer_load_dwordx4 v[16:19], v56, s[72:75], s96 offen sc1
    s_mov_b32 s96, 0x380400
    buffer_load_dwordx4 v[20:23], v56, s[72:75], s96 offen sc1
    s_waitcnt vmcnt(12)
    v_perm_b32 v144, v156, v152, s12
    v_perm_b32 v148, v156, v152, s13
    v_perm_b32 v145, v157, v153, s12
    v_perm_b32 v149, v157, v153, s13
    v_perm_b32 v146, v158, v154, s12
    v_perm_b32 v150, v158, v154, s13
    v_perm_b32 v147, v159, v155, s12
    v_perm_b32 v151, v159, v155, s13
    v_dot2c_f32_bf16 v200, v208, v144
    v_dot2c_f32_bf16 v201, v208, v148
    v_dot2c_f32_bf16 v202, v208, v145
    v_dot2c_f32_bf16 v203, v208, v149
    v_dot2c_f32_bf16 v204, v208, v146
    v_dot2c_f32_bf16 v205, v208, v150
    v_dot2c_f32_bf16 v206, v208, v147
    v_dot2c_f32_bf16 v207, v208, v151
    s_waitcnt vmcnt(10)
    v_perm_b32 v152, v164, v160, s12
    v_perm_b32 v156, v164, v160, s13
    v_perm_b32 v153, v165, v161, s12
    v_perm_b32 v157, v165, v161, s13
    v_perm_b32 v154, v166, v162, s12
    v_perm_b32 v158, v166, v162, s13
    v_perm_b32 v155, v167, v163, s12
    v_perm_b32 v159, v167, v163, s13
    v_dot2c_f32_bf16 v200, v208, v152
    v_dot2c_f32_bf16 v201, v208, v156
    v_dot2c_f32_bf16 v202, v208, v153
    v_dot2c_f32_bf16 v203, v208, v157
    v_dot2c_f32_bf16 v204, v208, v154
    v_dot2c_f32_bf16 v205, v208, v158
    v_dot2c_f32_bf16 v206, v208, v155
    v_dot2c_f32_bf16 v207, v208, v159
    s_waitcnt vmcnt(8)
    v_perm_b32 v160, v172, v168, s12
    v_perm_b32 v164, v172, v168, s13
    v_perm_b32 v161, v173, v169, s12
    v_perm_b32 v165, v173, v169, s13
    v_perm_b32 v162, v174, v170, s12
    v_perm_b32 v166, v174, v170, s13
    v_perm_b32 v163, v175, v171, s12
    v_perm_b32 v167, v175, v171, s13
    v_dot2c_f32_bf16 v200, v208, v160
    v_dot2c_f32_bf16 v201, v208, v164
    v_dot2c_f32_bf16 v202, v208, v161
    v_dot2c_f32_bf16 v203, v208, v165
    v_dot2c_f32_bf16 v204, v208, v162
    v_dot2c_f32_bf16 v205, v208, v166
    v_dot2c_f32_bf16 v206, v208, v163
    v_dot2c_f32_bf16 v207, v208, v167
    s_waitcnt vmcnt(6)
    v_perm_b32 v168, v180, v176, s12
    v_perm_b32 v172, v180, v176, s13
    v_perm_b32 v169, v181, v177, s12
    v_perm_b32 v173, v181, v177, s13
    v_perm_b32 v170, v182, v178, s12
    v_perm_b32 v174, v182, v178, s13
    v_perm_b32 v171, v183, v179, s12
    v_perm_b32 v175, v183, v179, s13
    v_dot2c_f32_bf16 v200, v208, v168
    v_dot2c_f32_bf16 v201, v208, v172
    v_dot2c_f32_bf16 v202, v208, v169
    v_dot2c_f32_bf16 v203, v208, v173
    v_dot2c_f32_bf16 v204, v208, v170
    v_dot2c_f32_bf16 v205, v208, v174
    v_dot2c_f32_bf16 v206, v208, v171
    v_dot2c_f32_bf16 v207, v208, v175
    s_waitcnt vmcnt(4)
    v_perm_b32 v176, v188, v184, s12
    v_perm_b32 v180, v188, v184, s13
    v_perm_b32 v177, v189, v185, s12
    v_perm_b32 v181, v189, v185, s13
    v_perm_b32 v178, v190, v186, s12
    v_perm_b32 v182, v190, v186, s13
    v_perm_b32 v179, v191, v187, s12
    v_perm_b32 v183, v191, v187, s13
    v_dot2c_f32_bf16 v200, v208, v176
    v_dot2c_f32_bf16 v201, v208, v180
    v_dot2c_f32_bf16 v202, v208, v177
    v_dot2c_f32_bf16 v203, v208, v181
    v_dot2c_f32_bf16 v204, v208, v178
    v_dot2c_f32_bf16 v205, v208, v182
    v_dot2c_f32_bf16 v206, v208, v179
    v_dot2c_f32_bf16 v207, v208, v183
    s_waitcnt vmcnt(2)
    v_perm_b32 v184, v196, v192, s12
    v_perm_b32 v188, v196, v192, s13
    v_perm_b32 v185, v197, v193, s12
    v_perm_b32 v189, v197, v193, s13
    v_perm_b32 v186, v198, v194, s12
    v_perm_b32 v190, v198, v194, s13
    v_perm_b32 v187, v199, v195, s12
    v_perm_b32 v191, v199, v195, s13
    v_dot2c_f32_bf16 v200, v208, v184
    v_dot2c_f32_bf16 v201, v208, v188
    v_dot2c_f32_bf16 v202, v208, v185
    v_dot2c_f32_bf16 v203, v208, v189
    v_dot2c_f32_bf16 v204, v208, v186
    v_dot2c_f32_bf16 v205, v208, v190
    v_dot2c_f32_bf16 v206, v208, v187
    v_dot2c_f32_bf16 v207, v208, v191
    v_permlane32_swap_b32 v200, v204
    v_permlane32_swap_b32 v201, v205
    v_permlane32_swap_b32 v202, v206
    v_permlane32_swap_b32 v203, v207
    v_pk_add_f32 v[200:201], v[200:201], v[204:205]
    v_pk_add_f32 v[202:203], v[202:203], v[206:207]
    v_add_u32 v200, 0x200, v200
    v_and_or_b32 v200, v200, s14, v5
    v_add_u32 v201, 0x200, v201
    v_and_or_b32 v201, v201, s14, v5
    v_add_u32 v202, 0x200, v202
    v_and_or_b32 v202, v202, s14, v5
    v_add_u32 v203, 0x200, v203
    v_and_or_b32 v203, v203, s14, v5
    s_nop 0
    s_branch L_bentry
L_poll_146:
    s_mov_b32 s96, 0x380000
    buffer_load_dwordx4 v[16:19], v56, s[72:75], s96 offen sc1
    s_mov_b32 s96, 0x380400
    buffer_load_dwordx4 v[20:23], v56, s[72:75], s96 offen sc1
L_bentry:
    s_waitcnt vmcnt(0)
    v_xor_b32 v16, s11, v16
    v_xor_b32 v17, s11, v17
    v_xor_b32 v18, s11, v18
    v_xor_b32 v19, s11, v19
    v_xor_b32 v20, s11, v20
    v_xor_b32 v21, s11, v21
    v_xor_b32 v22, s11, v22
    v_xor_b32 v23, s11, v23
    v_or3_b32 v24, v16, v17, v18
    v_or3_b32 v25, v19, v20, v21
    v_or_b32 v26, v22, v23
    v_or3_b32 v24, v24, v25, v26
    v_and_b32 v24, 0x3ff, v24
    v_cmp_ne_u32 s[100:101], 0, v24
    s_mov_b64 exec, -1
    s_cmp_lg_u64 s[100:101], 0
    s_nop 1
    s_cbranch_scc1 L_pollr_147
    v_pk_add_f32 v[16:17], v[16:17], v[20:21]
    v_pk_add_f32 v[18:19], v[18:19], v[22:23]
    s_nop 0
    v_add_f32_dpp v16, v16, v16 row_ror:8 row_mask:0xf bank_mask:0xf
    v_add_f32_dpp v17, v17, v17 row_ror:8 row_mask:0xf bank_mask:0xf
    v_add_f32_dpp v18, v18, v18 row_ror:8 row_mask:0xf bank_mask:0xf
    v_add_f32_dpp v19, v19, v19 row_ror:8 row_mask:0xf bank_mask:0xf
    v_mov_b32 v20, v16
    v_mov_b32 v21, v17
    v_mov_b32 v22, v18
    v_mov_b32 v23, v19
    v_permlane16_swap_b32 v20, v16
    v_permlane16_swap_b32 v21, v17
    v_permlane16_swap_b32 v22, v18
    v_permlane16_swap_b32 v23, v19
    v_pk_add_f32 v[16:17], v[16:17], v[20:21]
    v_pk_add_f32 v[18:19], v[18:19], v[22:23]
    v_cvt_pk_bf16_f32 v20, v16, v17
    v_cvt_pk_bf16_f32 v21, v18, v19
    v_lshlrev_b32 v16, 16, v20
    v_and_b32 v17, s15, v20
    v_lshlrev_b32 v18, 16, v21
    v_and_b32 v19, s15, v21
    v_pk_add_f32 v[16:17], v[16:17], v[212:213]
    v_pk_add_f32 v[18:19], v[18:19], v[214:215]
    v_cvt_pk_bf16_f32 v28, v16, v17
    v_cvt_pk_bf16_f32 v29, v18, v19
    s_cmp_lg_u32 s67, 3
    s_cbranch_scc1 L_hrep
    v_mov_b32 v24, s10
    v_lshl_or_b32 v16, v28, 16, v24
    v_and_or_b32 v17, v28, s15, v24
    v_lshl_or_b32 v18, v29, 16, v24
    v_and_or_b32 v19, v29, s15, v24
    s_mov_b32 exec_lo, 0xff
    s_mov_b32 exec_hi, 0xff
    s_cmp_eq_u32 s26, 0
    s_cbranch_scc1 L_sl_148
    buffer_store_dwordx4 v[16:19], v61, s[72:75], s17 offen
    s_nop 0
    s_branch L_sl_149
L_sl_148:
    buffer_store_dwordx4 v[16:19], v61, s[72:75], s17 offen sc1
    s_nop 1
L_sl_149:
    s_mov_b64 exec, -1
L_hrep:
    v_dot2c_f32_bf16_dpp v48, v28, v64 row_newbcast:0 row_mask:0xf bank_mask:0xf
    v_dot2c_f32_bf16_dpp v49, v28, v68 row_newbcast:0 row_mask:0xf bank_mask:0xf
    v_dot2c_f32_bf16_dpp v50, v28, v65 row_newbcast:0 row_mask:0xf bank_mask:0xf
    v_dot2c_f32_bf16_dpp v51, v28, v69 row_newbcast:0 row_mask:0xf bank_mask:0xf
    v_dot2c_f32_bf16_dpp v52, v28, v66 row_newbcast:0 row_mask:0xf bank_mask:0xf
    v_dot2c_f32_bf16_dpp v53, v28, v70 row_newbcast:0 row_mask:0xf bank_mask:0xf
    v_dot2c_f32_bf16_dpp v54, v28, v67 row_newbcast:0 row_mask:0xf bank_mask:0xf
    v_dot2c_f32_bf16_dpp v55, v28, v71 row_newbcast:0 row_mask:0xf bank_mask:0xf
    v_dot2c_f32_bf16_dpp v48, v29, v72 row_newbcast:0 row_mask:0xf bank_mask:0xf
    v_dot2c_f32_bf16_dpp v49, v29, v76 row_newbcast:0 row_mask:0xf bank_mask:0xf
    v_dot2c_f32_bf16_dpp v50, v29, v73 row_newbcast:0 row_mask:0xf bank_mask:0xf
    v_dot2c_f32_bf16_dpp v51, v29, v77 row_newbcast:0 row_mask:0xf bank_mask:0xf
    v_dot2c_f32_bf16_dpp v52, v29, v74 row_newbcast:0 row_mask:0xf bank_mask:0xf
    v_dot2c_f32_bf16_dpp v53, v29, v78 row_newbcast:0 row_mask:0xf bank_mask:0xf
    v_dot2c_f32_bf16_dpp v54, v29, v75 row_newbcast:0 row_mask:0xf bank_mask:0xf
    v_dot2c_f32_bf16_dpp v55, v29, v79 row_newbcast:0 row_mask:0xf bank_mask:0xf
    v_dot2c_f32_bf16_dpp v48, v28, v80 row_newbcast:1 row_mask:0xf bank_mask:0xf
    v_dot2c_f32_bf16_dpp v49, v28, v84 row_newbcast:1 row_mask:0xf bank_mask:0xf
    v_dot2c_f32_bf16_dpp v50, v28, v81 row_newbcast:1 row_mask:0xf bank_mask:0xf
    v_dot2c_f32_bf16_dpp v51, v28, v85 row_newbcast:1 row_mask:0xf bank_mask:0xf
    v_dot2c_f32_bf16_dpp v52, v28, v82 row_newbcast:1 row_mask:0xf bank_mask:0xf
    v_dot2c_f32_bf16_dpp v53, v28, v86 row_newbcast:1 row_mask:0xf bank_mask:0xf
    v_dot2c_f32_bf16_dpp v54, v28, v83 row_newbcast:1 row_mask:0xf bank_mask:0xf
    v_dot2c_f32_bf16_dpp v55, v28, v87 row_newbcast:1 row_mask:0xf bank_mask:0xf
    v_dot2c_f32_bf16_dpp v48, v29, v88 row_newbcast:1 row_mask:0xf bank_mask:0xf
    v_dot2c_f32_bf16_dpp v49, v29, v92 row_newbcast:1 row_mask:0xf bank_mask:0xf
    v_dot2c_f32_bf16_dpp v50, v29, v89 row_newbcast:1 row_mask:0xf bank_mask:0xf
    v_dot2c_f32_bf16_dpp v51, v29, v93 row_newbcast:1 row_mask:0xf bank_mask:0xf
    v_dot2c_f32_bf16_dpp v52, v29, v90 row_newbcast:1 row_mask:0xf bank_mask:0xf
    v_dot2c_f32_bf16_dpp v53, v29, v94 row_newbcast:1 row_mask:0xf bank_mask:0xf
    v_dot2c_f32_bf16_dpp v54, v29, v91 row_newbcast:1 row_mask:0xf bank_mask:0xf
    v_dot2c_f32_bf16_dpp v55, v29, v95 row_newbcast:1 row_mask:0xf bank_mask:0xf
    v_dot2c_f32_bf16_dpp v48, v28, v96 row_newbcast:2 row_mask:0xf bank_mask:0xf
    v_dot2c_f32_bf16_dpp v49, v28, v100 row_newbcast:2 row_mask:0xf bank_mask:0xf
    v_dot2c_f32_bf16_dpp v50, v28, v97 row_newbcast:2 row_mask:0xf bank_mask:0xf
    v_dot2c_f32_bf16_dpp v51, v28, v101 row_newbcast:2 row_mask:0xf bank_mask:0xf
    v_dot2c_f32_bf16_dpp v52, v28, v98 row_newbcast:2 row_mask:0xf bank_mask:0xf
    v_dot2c_f32_bf16_dpp v53, v28, v102 row_newbcast:2 row_mask:0xf bank_mask:0xf
    v_dot2c_f32_bf16_dpp v54, v28, v99 row_newbcast:2 row_mask:0xf bank_mask:0xf
    v_dot2c_f32_bf16_dpp v55, v28, v103 row_newbcast:2 row_mask:0xf bank_mask:0xf
    v_dot2c_f32_bf16_dpp v48, v29, v104 row_newbcast:2 row_mask:0xf bank_mask:0xf
    v_dot2c_f32_bf16_dpp v49, v29, v108 row_newbcast:2 row_mask:0xf bank_mask:0xf
    v_dot2c_f32_bf16_dpp v50, v29, v105 row_newbcast:2 row_mask:0xf bank_mask:0xf
    v_dot2c_f32_bf16_dpp v51, v29, v109 row_newbcast:2 row_mask:0xf bank_mask:0xf
    v_dot2c_f32_bf16_dpp v52, v29, v106 row_newbcast:2 row_mask:0xf bank_mask:0xf
    v_dot2c_f32_bf16_dpp v53, v29, v110 row_newbcast:2 row_mask:0xf bank_mask:0xf
    v_dot2c_f32_bf16_dpp v54, v29, v107 row_newbcast:2 row_mask:0xf bank_mask:0xf
    v_dot2c_f32_bf16_dpp v55, v29, v111 row_newbcast:2 row_mask:0xf bank_mask:0xf
    v_dot2c_f32_bf16_dpp v48, v28, v112 row_newbcast:3 row_mask:0xf bank_mask:0xf
    v_dot2c_f32_bf16_dpp v49, v28, v116 row_newbcast:3 row_mask:0xf bank_mask:0xf
    v_dot2c_f32_bf16_dpp v50, v28, v113 row_newbcast:3 row_mask:0xf bank_mask:0xf
    v_dot2c_f32_bf16_dpp v51, v28, v117 row_newbcast:3 row_mask:0xf bank_mask:0xf
    v_dot2c_f32_bf16_dpp v52, v28, v114 row_newbcast:3 row_mask:0xf bank_mask:0xf
    v_dot2c_f32_bf16_dpp v53, v28, v118 row_newbcast:3 row_mask:0xf bank_mask:0xf
    v_dot2c_f32_bf16_dpp v54, v28, v115 row_newbcast:3 row_mask:0xf bank_mask:0xf
    v_dot2c_f32_bf16_dpp v55, v28, v119 row_newbcast:3 row_mask:0xf bank_mask:0xf
    v_dot2c_f32_bf16_dpp v48, v29, v120 row_newbcast:3 row_mask:0xf bank_mask:0xf
    v_dot2c_f32_bf16_dpp v49, v29, v124 row_newbcast:3 row_mask:0xf bank_mask:0xf
    v_dot2c_f32_bf16_dpp v50, v29, v121 row_newbcast:3 row_mask:0xf bank_mask:0xf
    v_dot2c_f32_bf16_dpp v51, v29, v125 row_newbcast:3 row_mask:0xf bank_mask:0xf
    v_dot2c_f32_bf16_dpp v52, v29, v122 row_newbcast:3 row_mask:0xf bank_mask:0xf
    v_dot2c_f32_bf16_dpp v53, v29, v126 row_newbcast:3 row_mask:0xf bank_mask:0xf
    v_dot2c_f32_bf16_dpp v54, v29, v123 row_newbcast:3 row_mask:0xf bank_mask:0xf
    v_dot2c_f32_bf16_dpp v55, v29, v127 row_newbcast:3 row_mask:0xf bank_mask:0xf
    v_dot2c_f32_bf16_dpp v48, v28, v128 row_newbcast:4 row_mask:0xf bank_mask:0xf
    v_dot2c_f32_bf16_dpp v49, v28, v132 row_newbcast:4 row_mask:0xf bank_mask:0xf
    v_dot2c_f32_bf16_dpp v50, v28, v129 row_newbcast:4 row_mask:0xf bank_mask:0xf
    v_dot2c_f32_bf16_dpp v51, v28, v133 row_newbcast:4 row_mask:0xf bank_mask:0xf
    v_dot2c_f32_bf16_dpp v52, v28, v130 row_newbcast:4 row_mask:0xf bank_mask:0xf
    v_dot2c_f32_bf16_dpp v53, v28, v134 row_newbcast:4 row_mask:0xf bank_mask:0xf
    v_dot2c_f32_bf16_dpp v54, v28, v131 row_newbcast:4 row_mask:0xf bank_mask:0xf
    v_dot2c_f32_bf16_dpp v55, v28, v135 row_newbcast:4 row_mask:0xf bank_mask:0xf
    v_dot2c_f32_bf16_dpp v48, v29, v136 row_newbcast:4 row_mask:0xf bank_mask:0xf
    v_dot2c_f32_bf16_dpp v49, v29, v140 row_newbcast:4 row_mask:0xf bank_mask:0xf
    v_dot2c_f32_bf16_dpp v50, v29, v137 row_newbcast:4 row_mask:0xf bank_mask:0xf
    v_dot2c_f32_bf16_dpp v51, v29, v141 row_newbcast:4 row_mask:0xf bank_mask:0xf
    v_dot2c_f32_bf16_dpp v52, v29, v138 row_newbcast:4 row_mask:0xf bank_mask:0xf
    v_dot2c_f32_bf16_dpp v53, v29, v142 row_newbcast:4 row_mask:0xf bank_mask:0xf
    v_dot2c_f32_bf16_dpp v54, v29, v139 row_newbcast:4 row_mask:0xf bank_mask:0xf
    v_dot2c_f32_bf16_dpp v55, v29, v143 row_newbcast:4 row_mask:0xf bank_mask:0xf
    v_dot2c_f32_bf16_dpp v48, v28, v144 row_newbcast:5 row_mask:0xf bank_mask:0xf
    v_dot2c_f32_bf16_dpp v49, v28, v148 row_newbcast:5 row_mask:0xf bank_mask:0xf
    v_dot2c_f32_bf16_dpp v50, v28, v145 row_newbcast:5 row_mask:0xf bank_mask:0xf
    v_dot2c_f32_bf16_dpp v51, v28, v149 row_newbcast:5 row_mask:0xf bank_mask:0xf
    v_dot2c_f32_bf16_dpp v52, v28, v146 row_newbcast:5 row_mask:0xf bank_mask:0xf
    v_dot2c_f32_bf16_dpp v53, v28, v150 row_newbcast:5 row_mask:0xf bank_mask:0xf
    v_dot2c_f32_bf16_dpp v54, v28, v147 row_newbcast:5 row_mask:0xf bank_mask:0xf
    v_dot2c_f32_bf16_dpp v55, v28, v151 row_newbcast:5 row_mask:0xf bank_mask:0xf
    v_dot2c_f32_bf16_dpp v48, v29, v152 row_newbcast:5 row_mask:0xf bank_mask:0xf
    v_dot2c_f32_bf16_dpp v49, v29, v156 row_newbcast:5 row_mask:0xf bank_mask:0xf
    v_dot2c_f32_bf16_dpp v50, v29, v153 row_newbcast:5 row_mask:0xf bank_mask:0xf
    v_dot2c_f32_bf16_dpp v51, v29, v157 row_newbcast:5 row_mask:0xf bank_mask:0xf
    v_dot2c_f32_bf16_dpp v52, v29, v154 row_newbcast:5 row_mask:0xf bank_mask:0xf
    v_dot2c_f32_bf16_dpp v53, v29, v158 row_newbcast:5 row_mask:0xf bank_mask:0xf
    v_dot2c_f32_bf16_dpp v54, v29, v155 row_newbcast:5 row_mask:0xf bank_mask:0xf
    v_dot2c_f32_bf16_dpp v55, v29, v159 row_newbcast:5 row_mask:0xf bank_mask:0xf
    v_dot2c_f32_bf16_dpp v48, v28, v160 row_newbcast:6 row_mask:0xf bank_mask:0xf
    v_dot2c_f32_bf16_dpp v49, v28, v164 row_newbcast:6 row_mask:0xf bank_mask:0xf
    v_dot2c_f32_bf16_dpp v50, v28, v161 row_newbcast:6 row_mask:0xf bank_mask:0xf
    v_dot2c_f32_bf16_dpp v51, v28, v165 row_newbcast:6 row_mask:0xf bank_mask:0xf
    v_dot2c_f32_bf16_dpp v52, v28, v162 row_newbcast:6 row_mask:0xf bank_mask:0xf
    v_dot2c_f32_bf16_dpp v53, v28, v166 row_newbcast:6 row_mask:0xf bank_mask:0xf
    v_dot2c_f32_bf16_dpp v54, v28, v163 row_newbcast:6 row_mask:0xf bank_mask:0xf
    v_dot2c_f32_bf16_dpp v55, v28, v167 row_newbcast:6 row_mask:0xf bank_mask:0xf
    v_dot2c_f32_bf16_dpp v48, v29, v168 row_newbcast:6 row_mask:0xf bank_mask:0xf
    v_dot2c_f32_bf16_dpp v49, v29, v172 row_newbcast:6 row_mask:0xf bank_mask:0xf
    v_dot2c_f32_bf16_dpp v50, v29, v169 row_newbcast:6 row_mask:0xf bank_mask:0xf
    v_dot2c_f32_bf16_dpp v51, v29, v173 row_newbcast:6 row_mask:0xf bank_mask:0xf
    v_dot2c_f32_bf16_dpp v52, v29, v170 row_newbcast:6 row_mask:0xf bank_mask:0xf
    v_dot2c_f32_bf16_dpp v53, v29, v174 row_newbcast:6 row_mask:0xf bank_mask:0xf
    v_dot2c_f32_bf16_dpp v54, v29, v171 row_newbcast:6 row_mask:0xf bank_mask:0xf
    v_dot2c_f32_bf16_dpp v55, v29, v175 row_newbcast:6 row_mask:0xf bank_mask:0xf
    v_dot2c_f32_bf16_dpp v48, v28, v176 row_newbcast:7 row_mask:0xf bank_mask:0xf
    v_dot2c_f32_bf16_dpp v49, v28, v180 row_newbcast:7 row_mask:0xf bank_mask:0xf
    v_dot2c_f32_bf16_dpp v50, v28, v177 row_newbcast:7 row_mask:0xf bank_mask:0xf
    v_dot2c_f32_bf16_dpp v51, v28, v181 row_newbcast:7 row_mask:0xf bank_mask:0xf
    v_dot2c_f32_bf16_dpp v52, v28, v178 row_newbcast:7 row_mask:0xf bank_mask:0xf
    v_dot2c_f32_bf16_dpp v53, v28, v182 row_newbcast:7 row_mask:0xf bank_mask:0xf
    v_dot2c_f32_bf16_dpp v54, v28, v179 row_newbcast:7 row_mask:0xf bank_mask:0xf
    v_dot2c_f32_bf16_dpp v55, v28, v183 row_newbcast:7 row_mask:0xf bank_mask:0xf
    v_dot2c_f32_bf16_dpp v48, v29, v184 row_newbcast:7 row_mask:0xf bank_mask:0xf
    v_dot2c_f32_bf16_dpp v49, v29, v188 row_newbcast:7 row_mask:0xf bank_mask:0xf
    v_dot2c_f32_bf16_dpp v50, v29, v185 row_newbcast:7 row_mask:0xf bank_mask:0xf
    v_dot2c_f32_bf16_dpp v51, v29, v189 row_newbcast:7 row_mask:0xf bank_mask:0xf
    v_dot2c_f32_bf16_dpp v52, v29, v186 row_newbcast:7 row_mask:0xf bank_mask:0xf
    v_dot2c_f32_bf16_dpp v53, v29, v190 row_newbcast:7 row_mask:0xf bank_mask:0xf
    v_dot2c_f32_bf16_dpp v54, v29, v187 row_newbcast:7 row_mask:0xf bank_mask:0xf
    v_dot2c_f32_bf16_dpp v55, v29, v191 row_newbcast:7 row_mask:0xf bank_mask:0xf
    v_permlane32_swap_b32 v48, v52
    v_permlane32_swap_b32 v49, v53
    v_permlane32_swap_b32 v50, v54
    v_permlane32_swap_b32 v51, v55
    v_pk_add_f32 v[48:49], v[48:49], v[52:53]
    v_pk_add_f32 v[50:51], v[50:51], v[54:55]
    v_add_u32 v48, 0x200, v48
    v_and_or_b32 v48, v48, s14, v5
    v_add_u32 v49, 0x200, v49
    v_and_or_b32 v49, v49, s14, v5
    v_add_u32 v50, 0x200, v50
    v_and_or_b32 v50, v50, s14, v5
    v_add_u32 v51, 0x200, v51
    v_and_or_b32 v51, v51, s14, v5
    s_mov_b64 exec, s[18:19]
    s_cmp_eq_u32 s26, 0
    s_cbranch_scc1 L_sl_150
    buffer_store_dwordx4 v[48:51], v15, s[72:75], s66 offen
    buffer_store_dwordx4 v[200:203], v15, s[72:75], s20 offen
    s_nop 0
    s_branch L_sl_151
L_sl_150:
    buffer_store_dwordx4 v[48:51], v15, s[72:75], s66 offen sc1
    buffer_store_dwordx4 v[200:203], v15, s[72:75], s20 offen sc1
    s_nop 1
L_sl_151:
    s_mov_b64 exec, -1
    s_cmp_ge_u32 s22, 2
    s_cbranch_scc1 L_end
    v_lshlrev_b32 v212, 16, v28
    v_and_b32 v213, s15, v28
    v_lshlrev_b32 v214, 16, v29
    v_and_b32 v215, s15, v29
    s_cmp_eq_u32 s22, 0
    s_cselect_b32 s24, 0xff, 0
    s_cselect_b32 s25, 0, 0xff
    s_mov_b64 s[100:101], -1
L_poll_152:
    v_mov_b32 v20, s11
    v_mov_b32 v21, s11
    v_mov_b32 v22, s11
    v_mov_b32 v23, s11
    v_mov_b32 v28, s11
    v_mov_b32 v29, s11
    v_mov_b32 v30, s11
    v_mov_b32 v31, s11
    s_mov_b32 s96, 0x300000
    buffer_load_dwordx4 v[16:19], v44, s[72:75], s96 offen sc1
    s_mov_b32 s96, 0x308000
    s_and_b32 exec_hi, exec_hi, 0xffff
    s_cbranch_execz L_psk_154
    buffer_load_dwordx4 v[20:23], v44, s[72:75], s96 offen sc1
L_psk_154:
    s_mov_b64 exec, s[100:101]
    s_mov_b32 s96, 0x310000
    buffer_load_dwordx4 v[24:27], v44, s[72:75], s96 offen sc1
    s_mov_b32 s96, 0x318000
    s_and_b32 exec_hi, exec_hi, 0xffff
    s_cbranch_execz L_psk_155
    buffer_load_dwordx4 v[28:31], v44, s[72:75], s96 offen sc1
L_psk_155:
    s_mov_b64 exec, s[100:101]
    s_waitcnt vmcnt(0)
    v_xor_b32 v16, s11, v16
    v_xor_b32 v17, s11, v17
    v_xor_b32 v18, s11, v18
    v_xor_b32 v19, s11, v19
    v_xor_b32 v20, s11, v20
    v_xor_b32 v21, s11, v21
    v_xor_b32 v22, s11, v22
    v_xor_b32 v23, s11, v23
    v_xor_b32 v24, s11, v24
    v_xor_b32 v25, s11, v25
    v_xor_b32 v26, s11, v26
    v_xor_b32 v27, s11, v27
    v_xor_b32 v28, s11, v28
    v_xor_b32 v29, s11, v29
    v_xor_b32 v30, s11, v30
    v_xor_b32 v31, s11, v31
    v_or3_b32 v32, v16, v17, v18
    v_or3_b32 v33, v19, v20, v21
    v_or3_b32 v34, v22, v23, v24
    v_or3_b32 v35, v25, v26, v27
    v_or3_b32 v36, v28, v29, v30
    v_or3_b32 v32, v32, v33, v34
    v_or3_b32 v35, v35, v36, v31
    v_or_b32 v32, v32, v35
    v_and_b32 v32, 0x3ff, v32
    v_cmp_ne_u32 s[100:101], 0, v32
    s_mov_b64 exec, -1
    s_cmp_lg_u64 s[100:101], 0
    s_nop 1
    s_cbranch_scc1 L_pollr_153
    v_pk_add_f32 v[16:17], v[16:17], v[20:21]
    v_pk_add_f32 v[18:19], v[18:19], v[22:23]
    v_pk_add_f32 v[24:25], v[24:25], v[28:29]
    v_pk_add_f32 v[26:27], v[26:27], v[30:31]
    v_pk_add_f32 v[16:17], v[16:17], v[24:25]
    v_pk_add_f32 v[18:19], v[18:19], v[26:27]
    s_nop 1
    v_permlane32_swap_b32 v16, v18
    v_permlane32_swap_b32 v17, v19
    v_pk_add_f32 v[16:17], v[16:17], v[18:19]
    s_nop 1
    v_permlane16_swap_b32 v16, v17
    v_add_f32 v16, v16, v17
    s_nop 1
    v_add_f32_dpp v16, v16, v16 row_ror:8 row_mask:0xf bank_mask:0xf
    ds_write_b32 v57, v16 offset:9728
    s_waitcnt lgkmcnt(0)
    s_barrier
    s_cmp_lg_u32 s67, 0
    s_cbranch_scc1 L_end
    ds_read_b128 v[16:19], v47 offset:9728
    ds_read_b128 v[20:23], v47 offset:9856
    ds_read_b128 v[24:27], v47 offset:9984
    ds_read_b128 v[28:31], v47 offset:10112
    s_lshl_b32 s96, s65, 6
    s_waitcnt lgkmcnt(0)
    v_pk_add_f32 v[16:17], v[16:17], v[20:21]
    v_pk_add_f32 v[18:19], v[18:19], v[22:23]
    v_pk_add_f32 v[24:25], v[24:25], v[28:29]
    v_pk_add_f32 v[26:27], v[26:27], v[30:31]
    v_pk_add_f32 v[16:17], v[16:17], v[24:25]
    v_pk_add_f32 v[18:19], v[18:19], v[26:27]
    v_cvt_pk_bf16_f32 v20, v16, v17
    v_cvt_pk_bf16_f32 v21, v18, v19
    v_lshlrev_b32 v16, 16, v20
    v_and_b32 v17, s15, v20
    v_lshlrev_b32 v18, 16, v21
    v_and_b32 v19, s15, v21
    v_pk_add_f32 v[16:17], v[16:17], v[212:213]
    v_pk_add_f32 v[18:19], v[18:19], v[214:215]
    v_cvt_pk_bf16_f32 v20, v16, v17
    v_cvt_pk_bf16_f32 v21, v18, v19
    s_mov_b64 exec, s[24:25]
    buffer_store_dwordx2 v[20:21], v46, s[68:71], s96 offen
    s_mov_b64 exec, -1
    s_cmp_lg_u32 s65, 0
    s_cbranch_scc1 L_end
    v_mov_b32 v16, s78
    s_mov_b64 exec, 1
    buffer_store_dword v16, v7, s[72:75], 0 offen offset:0 sc1
    s_mov_b64 exec, -1
    s_branch L_end
L_pollr_135:
    s_sleep 8
    s_sub_u32 s76, s76, 1
    s_cmp_eq_u32 s76, 0
    s_cbranch_scc1 L_end
    s_mov_b64 exec, s[100:101]
    s_branch L_poll_134
L_pollr_141:
    s_sleep 8
    s_sub_u32 s76, s76, 1
    s_cmp_eq_u32 s76, 0
    s_cbranch_scc1 L_end
    s_mov_b64 exec, s[100:101]
    s_branch L_poll_140
L_pollr_147:
    s_sub_u32 s76, s76, 1
    s_cmp_eq_u32 s76, 0
    s_cbranch_scc1 L_end
    s_mov_b64 exec, s[100:101]
    s_branch L_poll_146
L_pollr_153:
    s_sub_u32 s76, s76, 1
    s_cmp_eq_u32 s76, 0
    s_cbranch_scc1 L_end
    s_mov_b64 exec, s[100:101]
    s_branch L_poll_152
L_end:
L_exit:
    s_endpgm
.section .rodata,"a"
.p2align 6
.amdhsa_kernel sequential_preLN__gqa_block_cached__glu_gated_geglu__decode_kernel
  .amdhsa_next_free_vgpr 256
  .amdhsa_next_free_sgpr 102
  .amdhsa_accum_offset 256
  .amdhsa_group_segment_fixed_size 0
  .amdhsa_kernarg_size 96
  .amdhsa_user_sgpr_count 2
  .amdhsa_user_sgpr_kernarg_segment_ptr 1
  .amdhsa_system_sgpr_workgroup_id_x 1
  .amdhsa_float_denorm_mode_32 3
.end_amdhsa_kernel
```
